```python
import torch

def _softmax(x, axis=-1):
    return torch.softmax(x, dim=axis)
def _gelu(x):
    return torch.nn.functional.gelu(x, approximate="tanh")
def _silu(x):
    return torch.nn.functional.silu(x)
def _sigmoid(x):
    return torch.sigmoid(x)
def _layernorm(x, axis=-1, eps=1e-5):
    m = x.mean(dim=axis, keepdim=True)
    v = x.var(dim=axis, keepdim=True, unbiased=False)
    return (x - m) / torch.sqrt(v + eps)
def _scatter_add(tgt, idx, src, axis=0):
    return tgt.clone().index_add_(axis, idx, src)
def _segment_sum(src, seg, n):
    out = torch.zeros((n,) + src.shape[1:], dtype=src.dtype)
    return out.index_add_(0, seg, src)
def _pad(x, pw):
    flat = tuple(v for pair in reversed(pw) for v in pair)
    return torch.nn.functional.pad(x, flat)

kernel_name = 'gated_mix__mha_block__glu_gated_glu__prompt'

def setup_inputs():

    _w = (lambda a: (lambda t: t.to(torch.bfloat16) if t.is_floating_point() else t)(torch.as_tensor(a)))
    def _A_setup():
        B, S, D, H = 1, 2048, 640, 32
        return {
            "x": _w((lambda *s: torch.randn(*s, dtype=torch.bfloat16) * 0.05)(B, S, D)),
            "wqkv": _w((lambda *s: torch.randn(*s, dtype=torch.bfloat16) * 0.8)(D, 3 * D)),
            "wo": _w((lambda *s: torch.randn(*s, dtype=torch.bfloat16) * 0.1)(D, D)),
        }
    _A_in = _A_setup()

    def _B_setup():
        B, S, D, F = 1, 2048, 640, 1728
        return {
            "x": _w((lambda *s: torch.randn(*s, dtype=torch.bfloat16) * 0.05)(B, S, D)),
            "w_gate": _w((lambda *s: torch.randn(*s, dtype=torch.bfloat16) * 0.8)(D, F)),
            "w_up": _w((lambda *s: torch.randn(*s, dtype=torch.bfloat16) * 0.05)(D, F)),
            "w_down": _w((lambda *s: torch.randn(*s, dtype=torch.bfloat16) * 0.05)(F, D)),
        }
    _B_in = _B_setup()

    return {
        "A_x": _A_in["x"],
        "A_wqkv": _A_in["wqkv"],
        "A_wo": _A_in["wo"],
        "B_x": _B_in["x"],
        "B_w_gate": _B_in["w_gate"],
        "B_w_up": _B_in["w_up"],
        "B_w_down": _B_in["w_down"],
        "gate_w": _w((lambda *s: torch.randn(*s, dtype=torch.bfloat16) * 0.05)(640) * 16.0),
    }

def reference(A_x, A_wqkv, A_wo, B_x, B_w_gate, B_w_up, B_w_down, gate_w):
    def _A_ref(x, wqkv, wo):
        B, S, D = x.shape
        H = 32
        Dh = D // H
        qkv = (lambda x, *d: x.permute(*d))((x @ wqkv).reshape(B, S, 3, H, Dh), 2, 0, 3, 1, 4)
        q, k, v = qkv[0], qkv[1], qkv[2]
        scores = torch.einsum("bhqd,bhkd->bhqk", q, k) * (Dh ** -0.5)
        p = _softmax(scores, axis=-1)
        o = torch.einsum("bhqk,bhkd->bhqd", p, v)
        return (lambda x, *d: x.permute(*d))(o, 0, 2, 1, 3).reshape(B, S, D) @ wo

    def _B_ref(x, w_gate, w_up, w_down):
        g = torch.einsum("bsd,df->bsf", x, w_gate)
        u = torch.einsum("bsd,df->bsf", x, w_up)
        h = _sigmoid(g) * u
        return torch.einsum("bsf,fd->bsd", h, w_down)

    x = A_x
    g = _sigmoid((x * gate_w).sum(-1, keepdims=True))
    a = _A_ref(x, A_wqkv, A_wo)
    b = _B_ref(x, B_w_gate, B_w_up, B_w_down)
    return g * a + (1 - g) * b
```

```asm
; @launch grid=(768,1,1) block=(256,1,1) lds=81920
.amdgcn_target "amdgcn-amd-amdhsa--gfx950"
.text
.globl gated_mix__mha_block__glu_gated_glu__prompt_kernel
.p2align 8
.type gated_mix__mha_block__glu_gated_glu__prompt_kernel,@function
gated_mix__mha_block__glu_gated_glu__prompt_kernel:
    s_cmp_ge_u32 s2, 768
    s_cbranch_scc1 L_end
    s_cmp_ge_u32 s2, 512
    s_cbranch_scc1 L_role_c
    s_cmp_ge_u32 s2, 256
    s_cbranch_scc1 L_role_b
    s_load_dwordx2 s[40:41], s[0:1], 0
    s_load_dwordx2 s[42:43], s[0:1], 8
    s_load_dwordx2 s[44:45], s[0:1], 80
    s_load_dwordx2 s[46:47], s[0:1], 56
    s_load_dwordx2 s[56:57], s[0:1], 72
    s_setprio 3
    s_and_b32 s30, s2, 1
    s_lshl_b32 s30, s30, 3
    s_bfe_u32 s31, s2, 0x30003
    s_add_u32 s30, s30, s31
    s_bfe_u32 s31, s2, 0x20001
    s_lshl_b32 s31, s31, 2
    s_lshr_b32 s32, s2, 6
    s_add_u32 s31, s31, s32
    v_and_b32 v1, 63, v0
    v_lshrrev_b32 v2, 6, v0
    s_nop 0
    v_readfirstlane_b32 s16, v2
    s_movk_i32 s24, 1280
    v_lshrrev_b32 v2, 3, v1
    v_and_b32 v3, 7, v1
    v_lshrrev_b32 v4, 1, v2
    v_mul_lo_u32 v5, v2, s24
    v_or_b32 v6, 0, v4
    v_xor_b32 v6, v6, v3
    v_lshl_add_u32 v6, v6, 4, v5
    v_add_u32 v8, 0, v6
    v_or_b32 v6, 4, v4
    v_xor_b32 v6, v6, v3
    v_lshl_add_u32 v6, v6, 4, v5
    v_add_u32 v9, 9216, v6
    v_or_b32 v6, 0, v4
    v_xor_b32 v6, v6, v3
    v_lshl_add_u32 v6, v6, 4, v5
    v_add_u32 v10, 18432, v6
    v_or_b32 v6, 4, v4
    v_xor_b32 v6, v6, v3
    v_lshl_add_u32 v6, v6, 4, v5
    v_add_u32 v11, 27648, v6
    s_movk_i32 s24, 3840
    v_mul_lo_u32 v5, v2, s24
    v_bfe_u32 v6, v1, 2, 1
    v_bfe_u32 v7, v1, 4, 1
    v_xor_b32 v6, v6, v7
    v_lshl_add_u32 v5, v6, 6, v5
    v_and_b32 v7, 3, v1
    v_lshl_add_u32 v12, v7, 4, v5
    v_add_u32 v13, 29696, v12
    s_waitcnt lgkmcnt(0)
    s_mov_b32 s4, s40
    s_and_b32 s5, s41, 0xffff
    s_mov_b32 s6, 2621440
    s_mov_b32 s7, 0x20000
    s_mov_b32 s8, s42
    s_and_b32 s9, s43, 0xffff
    s_mov_b32 s10, 2457600
    s_mov_b32 s11, 0x20000
    s_cmp_eq_u32 s31, 15
    s_cbranch_scc0 L_a_gemm
    s_mov_b32 s12, s44
    s_and_b32 s13, s45, 0xffff
    s_mov_b32 s14, 268435456
    s_mov_b32 s15, 0x20000
    s_mov_b32 s52, s46
    s_and_b32 s53, s47, 0xffff
    s_mov_b32 s54, 1280
    s_mov_b32 s55, 0x20000
    s_mov_b32 s48, s56
    s_and_b32 s49, s57, 0xffff
    s_mov_b32 s50, 256
    s_mov_b32 s51, 0x20000
    s_lshl_b32 s24, s30, 2
    s_add_u32 s24, s24, s16
    s_mul_i32 s18, s24, 40960
    s_lshl_b32 s21, s16, 12
    v_lshrrev_b32 v2, 5, v1
    v_lshlrev_b32 v21, 4, v2
    s_mov_b32 s22, 0
    s_add_u32 m0, s21, 0
    s_nop 0
    buffer_load_dwordx4 v8, s[4:7], s18 offen offset:0 lds
    buffer_load_dwordx4 v9, s[4:7], s18 offen offset:1024 lds
    buffer_load_dwordx4 v10, s[4:7], s18 offen offset:2048 lds
    buffer_load_dwordx4 v11, s[4:7], s18 offen offset:3072 lds
    s_add_u32 s18, s18, 128
    s_add_u32 m0, s21, 16384
    s_nop 0
    buffer_load_dwordx4 v8, s[4:7], s18 offen offset:0 lds
    buffer_load_dwordx4 v9, s[4:7], s18 offen offset:1024 lds
    buffer_load_dwordx4 v10, s[4:7], s18 offen offset:2048 lds
    buffer_load_dwordx4 v11, s[4:7], s18 offen offset:3072 lds
    s_add_u32 s18, s18, 128
    s_add_u32 m0, s21, 32768
    s_nop 0
    buffer_load_dwordx4 v8, s[4:7], s18 offen offset:0 lds
    buffer_load_dwordx4 v9, s[4:7], s18 offen offset:1024 lds
    buffer_load_dwordx4 v10, s[4:7], s18 offen offset:2048 lds
    buffer_load_dwordx4 v11, s[4:7], s18 offen offset:3072 lds
    s_add_u32 s18, s18, 128
    s_add_u32 m0, s21, 49152
    s_nop 0
    buffer_load_dwordx4 v8, s[4:7], s18 offen offset:0 lds
    buffer_load_dwordx4 v9, s[4:7], s18 offen offset:1024 lds
    buffer_load_dwordx4 v10, s[4:7], s18 offen offset:2048 lds
    buffer_load_dwordx4 v11, s[4:7], s18 offen offset:3072 lds
    s_add_u32 s18, s18, 128
    s_add_u32 m0, s21, 65536
    s_nop 0
    buffer_load_dwordx4 v8, s[4:7], s18 offen offset:0 lds
    buffer_load_dwordx4 v9, s[4:7], s18 offen offset:1024 lds
    buffer_load_dwordx4 v10, s[4:7], s18 offen offset:2048 lds
    buffer_load_dwordx4 v11, s[4:7], s18 offen offset:3072 lds
    s_add_u32 s18, s18, 128
    buffer_load_dwordx4 v[112:115], v21, s[52:55], s22 offen offset:0
    buffer_load_dwordx4 v[116:119], v21, s[52:55], s22 offen offset:32
    buffer_load_dwordx4 v[120:123], v21, s[52:55], s22 offen offset:64
    buffer_load_dwordx4 v[124:127], v21, s[52:55], s22 offen offset:96
    buffer_load_dwordx4 v[128:131], v21, s[52:55], s22 offen offset:128
    buffer_load_dwordx4 v[132:135], v21, s[52:55], s22 offen offset:160
    buffer_load_dwordx4 v[136:139], v21, s[52:55], s22 offen offset:192
    buffer_load_dwordx4 v[140:143], v21, s[52:55], s22 offen offset:224
    buffer_load_dwordx4 v[144:147], v21, s[52:55], s22 offen offset:256
    buffer_load_dwordx4 v[148:151], v21, s[52:55], s22 offen offset:288
    buffer_load_dwordx4 v[152:155], v21, s[52:55], s22 offen offset:320
    buffer_load_dwordx4 v[156:159], v21, s[52:55], s22 offen offset:352
    buffer_load_dwordx4 v[160:163], v21, s[52:55], s22 offen offset:384
    buffer_load_dwordx4 v[164:167], v21, s[52:55], s22 offen offset:416
    buffer_load_dwordx4 v[168:171], v21, s[52:55], s22 offen offset:448
    buffer_load_dwordx4 v[172:175], v21, s[52:55], s22 offen offset:480
    buffer_load_dwordx4 v[176:179], v21, s[52:55], s22 offen offset:512
    buffer_load_dwordx4 v[180:183], v21, s[52:55], s22 offen offset:544
    buffer_load_dwordx4 v[184:187], v21, s[52:55], s22 offen offset:576
    buffer_load_dwordx4 v[188:191], v21, s[52:55], s22 offen offset:608
    v_and_b32 v2, 31, v1
    v_lshrrev_b32 v3, 5, v1
    v_bfe_u32 v4, v1, 1, 3
    s_lshr_b32 s24, s16, 1
    s_lshl_b32 s24, s24, 13
    v_lshlrev_b32 v5, 7, v2
    v_add_u32 v5, s24, v5
    v_or_b32 v6, 0, v3
    v_xor_b32 v6, v6, v4
    v_lshl_add_u32 v16, v6, 4, v5
    v_or_b32 v6, 2, v3
    v_xor_b32 v6, v6, v4
    v_lshl_add_u32 v17, v6, 4, v5
    v_or_b32 v6, 4, v3
    v_xor_b32 v6, v6, v4
    v_lshl_add_u32 v18, v6, 4, v5
    v_or_b32 v6, 6, v3
    v_xor_b32 v6, v6, v4
    v_lshl_add_u32 v19, v6, 4, v5
    v_bfe_u32 v2, v1, 2, 2
    v_lshl_add_u32 v4, v3, 3, v2
    v_lshlrev_b32 v4, 7, v4
    v_lshrrev_b32 v2, 1, v2
    s_and_b32 s24, s16, 1
    v_xor_b32 v2, s24, v2
    v_lshl_add_u32 v4, v2, 6, v4
    v_bfe_u32 v2, v1, 4, 1
    v_lshl_add_u32 v4, v2, 5, v4
    v_and_b32 v2, 3, v1
    v_lshl_add_u32 v4, v2, 3, v4
    v_add_u32 v20, 49152, v4
    s_and_b32 s24, s16, 1
    s_lshl_b32 s24, s24, 12
    v_add_u32 v16, s24, v16
    v_add_u32 v17, s24, v17
    v_add_u32 v18, s24, v18
    v_add_u32 v19, s24, v19
    v_mov_b32 v204, 0
    v_mov_b32 v205, 0
    v_mov_b32 v206, 0
    v_mov_b32 v207, 0
    v_mov_b32 v208, 0
    v_mov_b32 v209, 0
    v_mov_b32 v210, 0
    v_mov_b32 v211, 0
    v_mov_b32 v212, 0
    v_mov_b32 v213, 0
    v_mov_b32 v214, 0
    v_mov_b32 v215, 0
    v_mov_b32 v216, 0
    v_mov_b32 v217, 0
    v_mov_b32 v218, 0
    v_mov_b32 v219, 0
L_gate_loop:
    s_waitcnt vmcnt(0)
    s_barrier
    ds_read_b128 v[32:35], v16 offset:0
    ds_read_b128 v[36:39], v17 offset:0
    ds_read_b128 v[40:43], v18 offset:0
    ds_read_b128 v[44:47], v19 offset:0
    ds_read_b128 v[48:51], v16 offset:16384
    ds_read_b128 v[52:55], v17 offset:16384
    ds_read_b128 v[56:59], v18 offset:16384
    ds_read_b128 v[60:63], v19 offset:16384
    ds_read_b128 v[64:67], v16 offset:32768
    ds_read_b128 v[68:71], v17 offset:32768
    ds_read_b128 v[72:75], v18 offset:32768
    ds_read_b128 v[76:79], v19 offset:32768
    ds_read_b128 v[80:83], v16 offset:49152
    ds_read_b128 v[84:87], v17 offset:49152
    ds_read_b128 v[88:91], v18 offset:49152
    ds_read_b128 v[92:95], v19 offset:49152
    v_add_u32 v2, 65536, v16
    ds_read_b128 v[96:99], v2
    v_add_u32 v2, 65536, v17
    ds_read_b128 v[100:103], v2
    v_add_u32 v2, 65536, v18
    ds_read_b128 v[104:107], v2
    v_add_u32 v2, 65536, v19
    ds_read_b128 v[108:111], v2
    s_waitcnt lgkmcnt(0)
    s_barrier
    s_add_u32 s22, s22, 640
    v_mfma_f32_32x32x16_bf16 v[204:219], v[112:115], v[32:35], v[204:219]
    v_mfma_f32_32x32x16_bf16 v[204:219], v[116:119], v[36:39], v[204:219]
    v_mfma_f32_32x32x16_bf16 v[204:219], v[120:123], v[40:43], v[204:219]
    v_mfma_f32_32x32x16_bf16 v[204:219], v[124:127], v[44:47], v[204:219]
    v_mfma_f32_32x32x16_bf16 v[204:219], v[128:131], v[48:51], v[204:219]
    v_mfma_f32_32x32x16_bf16 v[204:219], v[132:135], v[52:55], v[204:219]
    v_mfma_f32_32x32x16_bf16 v[204:219], v[136:139], v[56:59], v[204:219]
    v_mfma_f32_32x32x16_bf16 v[204:219], v[140:143], v[60:63], v[204:219]
    v_mfma_f32_32x32x16_bf16 v[204:219], v[144:147], v[64:67], v[204:219]
    v_mfma_f32_32x32x16_bf16 v[204:219], v[148:151], v[68:71], v[204:219]
    v_mfma_f32_32x32x16_bf16 v[204:219], v[152:155], v[72:75], v[204:219]
    v_mfma_f32_32x32x16_bf16 v[204:219], v[156:159], v[76:79], v[204:219]
    v_mfma_f32_32x32x16_bf16 v[204:219], v[160:163], v[80:83], v[204:219]
    v_mfma_f32_32x32x16_bf16 v[204:219], v[164:167], v[84:87], v[204:219]
    v_mfma_f32_32x32x16_bf16 v[204:219], v[168:171], v[88:91], v[204:219]
    v_mfma_f32_32x32x16_bf16 v[204:219], v[172:175], v[92:95], v[204:219]
    v_mfma_f32_32x32x16_bf16 v[204:219], v[176:179], v[96:99], v[204:219]
    v_mfma_f32_32x32x16_bf16 v[204:219], v[180:183], v[100:103], v[204:219]
    v_mfma_f32_32x32x16_bf16 v[204:219], v[184:187], v[104:107], v[204:219]
    v_mfma_f32_32x32x16_bf16 v[204:219], v[188:191], v[108:111], v[204:219]
    s_cmp_ge_u32 s22, 1280
    s_cbranch_scc1 L_gate_done
    s_add_u32 m0, s21, 0
    s_nop 0
    buffer_load_dwordx4 v8, s[4:7], s18 offen offset:0 lds
    buffer_load_dwordx4 v9, s[4:7], s18 offen offset:1024 lds
    buffer_load_dwordx4 v10, s[4:7], s18 offen offset:2048 lds
    buffer_load_dwordx4 v11, s[4:7], s18 offen offset:3072 lds
    s_add_u32 s18, s18, 128
    s_add_u32 m0, s21, 16384
    s_nop 0
    buffer_load_dwordx4 v8, s[4:7], s18 offen offset:0 lds
    buffer_load_dwordx4 v9, s[4:7], s18 offen offset:1024 lds
    buffer_load_dwordx4 v10, s[4:7], s18 offen offset:2048 lds
    buffer_load_dwordx4 v11, s[4:7], s18 offen offset:3072 lds
    s_add_u32 s18, s18, 128
    s_add_u32 m0, s21, 32768
    s_nop 0
    buffer_load_dwordx4 v8, s[4:7], s18 offen offset:0 lds
    buffer_load_dwordx4 v9, s[4:7], s18 offen offset:1024 lds
    buffer_load_dwordx4 v10, s[4:7], s18 offen offset:2048 lds
    buffer_load_dwordx4 v11, s[4:7], s18 offen offset:3072 lds
    s_add_u32 s18, s18, 128
    s_add_u32 m0, s21, 49152
    s_nop 0
    buffer_load_dwordx4 v8, s[4:7], s18 offen offset:0 lds
    buffer_load_dwordx4 v9, s[4:7], s18 offen offset:1024 lds
    buffer_load_dwordx4 v10, s[4:7], s18 offen offset:2048 lds
    buffer_load_dwordx4 v11, s[4:7], s18 offen offset:3072 lds
    s_add_u32 s18, s18, 128
    s_add_u32 m0, s21, 65536
    s_nop 0
    buffer_load_dwordx4 v8, s[4:7], s18 offen offset:0 lds
    buffer_load_dwordx4 v9, s[4:7], s18 offen offset:1024 lds
    buffer_load_dwordx4 v10, s[4:7], s18 offen offset:2048 lds
    buffer_load_dwordx4 v11, s[4:7], s18 offen offset:3072 lds
    s_add_u32 s18, s18, 128
    buffer_load_dwordx4 v[112:115], v21, s[52:55], s22 offen offset:0
    buffer_load_dwordx4 v[116:119], v21, s[52:55], s22 offen offset:32
    buffer_load_dwordx4 v[120:123], v21, s[52:55], s22 offen offset:64
    buffer_load_dwordx4 v[124:127], v21, s[52:55], s22 offen offset:96
    buffer_load_dwordx4 v[128:131], v21, s[52:55], s22 offen offset:128
    buffer_load_dwordx4 v[132:135], v21, s[52:55], s22 offen offset:160
    buffer_load_dwordx4 v[136:139], v21, s[52:55], s22 offen offset:192
    buffer_load_dwordx4 v[140:143], v21, s[52:55], s22 offen offset:224
    buffer_load_dwordx4 v[144:147], v21, s[52:55], s22 offen offset:256
    buffer_load_dwordx4 v[148:151], v21, s[52:55], s22 offen offset:288
    buffer_load_dwordx4 v[152:155], v21, s[52:55], s22 offen offset:320
    buffer_load_dwordx4 v[156:159], v21, s[52:55], s22 offen offset:352
    buffer_load_dwordx4 v[160:163], v21, s[52:55], s22 offen offset:384
    buffer_load_dwordx4 v[164:167], v21, s[52:55], s22 offen offset:416
    buffer_load_dwordx4 v[168:171], v21, s[52:55], s22 offen offset:448
    buffer_load_dwordx4 v[172:175], v21, s[52:55], s22 offen offset:480
    buffer_load_dwordx4 v[176:179], v21, s[52:55], s22 offen offset:512
    buffer_load_dwordx4 v[180:183], v21, s[52:55], s22 offen offset:544
    buffer_load_dwordx4 v[184:187], v21, s[52:55], s22 offen offset:576
    buffer_load_dwordx4 v[188:191], v21, s[52:55], s22 offen offset:608
    s_branch L_gate_loop
L_gate_done:
    s_nop 15
    v_mul_f32 v8, 0xbfb8aa3b, v204
    v_exp_f32 v8, v8
    s_nop 0
    v_add_f32 v8, 1.0, v8
    v_rcp_f32 v8, v8
    v_and_b32 v9, 31, v1
    s_lshl_b32 s24, s30, 2
    s_add_u32 s24, s24, s16
    s_lshl_b32 s24, s24, 5
    v_add_u32 v9, s24, v9
    v_lshlrev_b32 v9, 2, v9
    v_cmp_gt_u32 vcc, 32, v1
    s_mov_b32 s23, 7864320
    s_and_saveexec_b64 s[24:25], vcc
    buffer_store_dword v8, v9, s[12:15], s23 offen sc1
    s_mov_b64 exec, s[24:25]
    v_mov_b32 v202, 0
    buffer_load_dwordx2 v[200:201], v202, s[48:51], 0 offen sc1
    s_waitcnt vmcnt(0)
    s_mov_b32 s59, 0
L_a_e0n_nl:
    s_memrealtime s[56:57]
    v_readfirstlane_b32 s60, v200
    v_readfirstlane_b32 s61, v201
    s_nop 1
    s_min_u32 s58, s60, s61
    s_cmp_lg_u32 s58, 0
    s_cbranch_scc0 L_a_e0n_nr
    s_waitcnt lgkmcnt(0)
    s_sub_u32 s58, s56, s60
    s_add_u32 s58, s58, 500
    s_cmp_lt_u32 s58, 3000
    s_cbranch_scc1 L_a_e0n_nd
    s_cmp_ge_u32 s59, 64
    s_cbranch_scc1 L_a_e0n_nd
L_a_e0n_nr:
    s_waitcnt lgkmcnt(0)
    s_add_u32 s59, s59, 1
    s_cmp_ge_u32 s59, 0x20000
    s_cbranch_scc1 L_a_e0n_nd
    s_sleep 4
    buffer_load_dwordx2 v[200:201], v202, s[48:51], 0 offen sc1
    s_waitcnt vmcnt(0)
    s_branch L_a_e0n_nl
L_a_e0n_nd:
    s_branch L_a_sig
L_a_gemm:
    s_lshr_b32 s33, s16, 1
    s_lshl_b32 s33, s33, 7
    s_lshl_b32 s34, s31, 8
    s_add_u32 s33, s33, s34
    s_lshl_b32 s24, s30, 2
    s_add_u32 s24, s24, s16
    s_mul_i32 s18, s24, 40960
    s_and_b32 s24, s16, 1
    s_mul_i32 s24, s24, 61440
    s_add_u32 s19, s24, s33
    s_mov_b32 s20, 122880
    s_lshl_b32 s21, s16, 12
    s_lshl_b32 s23, s16, 11
    s_add_u32 s23, s23, 49152
    s_mov_b32 m0, s21
    s_nop 0
    buffer_load_dwordx4 v8, s[4:7], s18 offen offset:0 lds
    buffer_load_dwordx4 v9, s[4:7], s18 offen offset:1024 lds
    s_mov_b32 m0, s23
    s_nop 0
    buffer_load_dwordx4 v12, s[8:11], s19 offen offset:0 lds
    buffer_load_dwordx4 v13, s[8:11], s19 offen offset:1024 lds
    s_add_u32 s19, s19, s20
    s_add_u32 s23, s23, 8192
    s_cmp_ge_u32 s23, 81920
    s_cselect_b32 s24, 32768, 0
    s_sub_u32 s23, s23, s24
    s_mov_b32 m0, s21
    s_nop 0
    buffer_load_dwordx4 v10, s[4:7], s18 offen offset:2048 lds
    buffer_load_dwordx4 v11, s[4:7], s18 offen offset:3072 lds
    s_add_u32 s18, s18, 128
    s_add_u32 s21, s21, 16384
    s_cmp_ge_u32 s21, 49152
    s_cselect_b32 s24, 49152, 0
    s_sub_u32 s21, s21, s24
    s_mov_b32 m0, s23
    s_nop 0
    buffer_load_dwordx4 v12, s[8:11], s19 offen offset:0 lds
    buffer_load_dwordx4 v13, s[8:11], s19 offen offset:1024 lds
    s_add_u32 s19, s19, s20
    s_add_u32 s23, s23, 8192
    s_cmp_ge_u32 s23, 81920
    s_cselect_b32 s24, 32768, 0
    s_sub_u32 s23, s23, s24
    s_mov_b32 m0, s21
    s_nop 0
    buffer_load_dwordx4 v8, s[4:7], s18 offen offset:0 lds
    buffer_load_dwordx4 v9, s[4:7], s18 offen offset:1024 lds
    s_mov_b32 m0, s23
    s_nop 0
    buffer_load_dwordx4 v12, s[8:11], s19 offen offset:0 lds
    buffer_load_dwordx4 v13, s[8:11], s19 offen offset:1024 lds
    s_add_u32 s19, s19, s20
    s_add_u32 s23, s23, 8192
    s_cmp_ge_u32 s23, 81920
    s_cselect_b32 s24, 32768, 0
    s_sub_u32 s23, s23, s24
    s_mov_b32 m0, s21
    s_nop 0
    buffer_load_dwordx4 v10, s[4:7], s18 offen offset:2048 lds
    buffer_load_dwordx4 v11, s[4:7], s18 offen offset:3072 lds
    s_add_u32 s18, s18, 128
    s_add_u32 s21, s21, 16384
    s_cmp_ge_u32 s21, 49152
    s_cselect_b32 s24, 49152, 0
    s_sub_u32 s21, s21, s24
    s_mov_b32 s12, s44
    s_and_b32 s13, s45, 0xffff
    s_mov_b32 s14, 268435456
    s_mov_b32 s15, 0x20000
    s_mov_b32 s52, s46
    s_and_b32 s53, s47, 0xffff
    s_mov_b32 s54, 1280
    s_mov_b32 s55, 0x20000
    s_mov_b32 s48, s56
    s_and_b32 s49, s57, 0xffff
    s_mov_b32 s50, 256
    s_mov_b32 s51, 0x20000
    s_cmp_eq_u32 s2, 0
    s_cbranch_scc0 L_a_nonz
    v_cmp_eq_u32 vcc, 0, v0
    s_and_saveexec_b64 s[58:59], vcc
    s_cbranch_execz L_a_nonz0
    s_memrealtime s[60:61]
    s_waitcnt lgkmcnt(0)
    s_or_b32 s61, s61, 0x40000000
    s_or_b32 s60, s60, 1
    v_mov_b32 v2, s60
    v_mov_b32 v3, s61
    v_mov_b32 v4, 0
    buffer_store_dwordx2 v[2:3], v4, s[48:51], 0 offen sc1
L_a_nonz0:
    s_mov_b64 exec, s[58:59]
L_a_nonz:
    v_and_b32 v2, 31, v1
    v_lshrrev_b32 v3, 5, v1
    v_bfe_u32 v4, v1, 1, 3
    s_lshr_b32 s24, s16, 1
    s_lshl_b32 s24, s24, 13
    v_lshlrev_b32 v5, 7, v2
    v_add_u32 v5, s24, v5
    v_or_b32 v6, 0, v3
    v_xor_b32 v6, v6, v4
    v_lshl_add_u32 v16, v6, 4, v5
    v_or_b32 v6, 2, v3
    v_xor_b32 v6, v6, v4
    v_lshl_add_u32 v17, v6, 4, v5
    v_or_b32 v6, 4, v3
    v_xor_b32 v6, v6, v4
    v_lshl_add_u32 v18, v6, 4, v5
    v_or_b32 v6, 6, v3
    v_xor_b32 v6, v6, v4
    v_lshl_add_u32 v19, v6, 4, v5
    v_bfe_u32 v2, v1, 2, 2
    v_lshl_add_u32 v4, v3, 3, v2
    v_lshlrev_b32 v4, 7, v4
    v_lshrrev_b32 v2, 1, v2
    s_and_b32 s24, s16, 1
    v_xor_b32 v2, s24, v2
    v_lshl_add_u32 v4, v2, 6, v4
    v_bfe_u32 v2, v1, 4, 1
    v_lshl_add_u32 v4, v2, 5, v4
    v_and_b32 v2, 3, v1
    v_lshl_add_u32 v4, v2, 3, v4
    v_add_u32 v20, 49152, v4
    s_lshr_b32 s33, s16, 1
    s_lshl_b32 s33, s33, 1
    s_lshl_b32 s34, s30, 2
    s_add_u32 s35, s33, s34
    s_cmp_ge_u32 s31, 10
    s_cbranch_scc1 L_a_v
    s_cmp_ge_u32 s31, 5
    s_cselect_b32 s36, 5, 0
    s_mov_b32 s37, 2560
    s_mov_b32 s38, 40960
    s_cselect_b32 s38, 81920, s38
    s_mov_b32 s39, 0
    s_cselect_b32 s39, 2621440, s39
    s_sub_u32 s36, s31, s36
    s_lshl_b32 s36, s36, 4
    s_and_b32 s47, s16, 1
    s_lshl_b32 s47, s47, 2
    s_add_u32 s36, s36, s47
    s_mul_i32 s44, s35, s38
    s_add_u32 s44, s44, s39
    s_add_u32 s45, s44, s38
    v_lshrrev_b32 v24, 5, v1
    v_add_u32 v24, s36, v24
    v_and_b32 v25, 31, v1
    v_lshlrev_b32 v25, 4, v25
    v_add_u32 v26, 0, v24
    v_mul_u32_u24 v27, 205, v26
    v_lshrrev_b32 v27, 10, v27
    v_mul_u32_u24 v28, 5, v27
    v_sub_u32 v28, v26, v28
    v_cmp_lt_u32 vcc, 2, v28
    v_lshlrev_b32 v29, 9, v28
    v_subrev_u32 v26, 512, v29
    v_cndmask_b32 v29, v29, v26, vcc
    v_cmp_eq_u32 vcc, 2, v28
    v_mov_b32 v26, 2048
    v_mad_u32_u24 v27, v27, s37, v25
    v_cndmask_b32 v29, v29, v26, vcc
    v_add_u32 v204, v29, v27
    v_add_u32 v26, 2, v24
    v_mul_u32_u24 v27, 205, v26
    v_lshrrev_b32 v27, 10, v27
    v_mul_u32_u24 v28, 5, v27
    v_sub_u32 v28, v26, v28
    v_cmp_lt_u32 vcc, 2, v28
    v_lshlrev_b32 v29, 9, v28
    v_subrev_u32 v26, 512, v29
    v_cndmask_b32 v29, v29, v26, vcc
    v_cmp_eq_u32 vcc, 2, v28
    v_mov_b32 v26, 2048
    v_mad_u32_u24 v27, v27, s37, v25
    v_cndmask_b32 v29, v29, v26, vcc
    v_add_u32 v205, v29, v27
    v_add_u32 v26, 8, v24
    v_mul_u32_u24 v27, 205, v26
    v_lshrrev_b32 v27, 10, v27
    v_mul_u32_u24 v28, 5, v27
    v_sub_u32 v28, v26, v28
    v_cmp_lt_u32 vcc, 2, v28
    v_lshlrev_b32 v29, 9, v28
    v_subrev_u32 v26, 512, v29
    v_cndmask_b32 v29, v29, v26, vcc
    v_cmp_eq_u32 vcc, 2, v28
    v_mov_b32 v26, 2048
    v_mad_u32_u24 v27, v27, s37, v25
    v_cndmask_b32 v29, v29, v26, vcc
    v_add_u32 v206, v29, v27
    v_add_u32 v26, 10, v24
    v_mul_u32_u24 v27, 205, v26
    v_lshrrev_b32 v27, 10, v27
    v_mul_u32_u24 v28, 5, v27
    v_sub_u32 v28, v26, v28
    v_cmp_lt_u32 vcc, 2, v28
    v_lshlrev_b32 v29, 9, v28
    v_subrev_u32 v26, 512, v29
    v_cndmask_b32 v29, v29, v26, vcc
    v_cmp_eq_u32 vcc, 2, v28
    v_mov_b32 v26, 2048
    v_mad_u32_u24 v27, v27, s37, v25
    v_cndmask_b32 v29, v29, v26, vcc
    v_add_u32 v207, v29, v27
    s_mov_b32 s46, 0x3ea52b5c
    s_mov_b32 s47, 0x3ea52b5c
    s_mov_b32 s17, 0
    s_mov_b32 s27, 0
    s_mov_b32 s29, 1
    s_waitcnt vmcnt(8) lgkmcnt(0)
    s_barrier
    ds_read_b128 v[24:27], v16 offset:0
    ds_read_b128 v[28:31], v16 offset:4096
    ds_read_b64_tr_b16 v[32:33], v20 offset:0
    s_mov_b32 m0, s23
    ds_read_b64_tr_b16 v[34:35], v20 offset:512
    ds_read_b64_tr_b16 v[36:37], v20 offset:4096
    ds_read_b64_tr_b16 v[38:39], v20 offset:4608
    buffer_load_dwordx4 v12, s[8:11], s19 offen offset:0 lds
    buffer_load_dwordx4 v13, s[8:11], s19 offen offset:1024 lds
    s_add_u32 s19, s19, s20
    s_add_u32 s23, s23, 8192
    s_cmp_ge_u32 s23, 81920
    s_cselect_b32 s24, 32768, 0
    s_sub_u32 s23, s23, s24
    s_add_u32 s17, s17, 1
    s_and_b32 s17, s17, 3
    s_mov_b32 s26, 8192
    s_cselect_b32 s26, s26, 0xffffa000
    s_waitcnt lgkmcnt(0)
    v_mfma_f32_32x32x16_bf16 v[56:71], v[32:35], v[24:27], 0
    ds_read_b128 v[40:43], v17 offset:0
    ds_read_b128 v[44:47], v17 offset:4096
    ds_read_b64_tr_b16 v[48:49], v20 offset:2048
    s_mov_b32 m0, s21
    v_mfma_f32_32x32x16_bf16 v[72:87], v[36:39], v[24:27], 0
    ds_read_b64_tr_b16 v[50:51], v20 offset:2560
    ds_read_b64_tr_b16 v[52:53], v20 offset:6144
    ds_read_b64_tr_b16 v[54:55], v20 offset:6656
    buffer_load_dwordx4 v8, s[4:7], s18 offen offset:0 lds
    v_mfma_f32_32x32x16_bf16 v[88:103], v[32:35], v[28:31], 0
    buffer_load_dwordx4 v9, s[4:7], s18 offen offset:1024 lds
    v_mfma_f32_32x32x16_bf16 v[104:119], v[36:39], v[28:31], 0
    v_add_u32 v20, s26, v20
    s_waitcnt vmcnt(8) lgkmcnt(0)
    s_barrier
    v_mfma_f32_32x32x16_bf16 v[56:71], v[48:51], v[40:43], v[56:71]
    ds_read_b128 v[24:27], v18 offset:0
    ds_read_b128 v[28:31], v18 offset:4096
    ds_read_b64_tr_b16 v[32:33], v20 offset:0
    s_mov_b32 m0, s23
    v_mfma_f32_32x32x16_bf16 v[72:87], v[52:55], v[40:43], v[72:87]
    ds_read_b64_tr_b16 v[34:35], v20 offset:512
    ds_read_b64_tr_b16 v[36:37], v20 offset:4096
    ds_read_b64_tr_b16 v[38:39], v20 offset:4608
    buffer_load_dwordx4 v12, s[8:11], s19 offen offset:0 lds
    v_mfma_f32_32x32x16_bf16 v[88:103], v[48:51], v[44:47], v[88:103]
    buffer_load_dwordx4 v13, s[8:11], s19 offen offset:1024 lds
    s_add_u32 s19, s19, s20
    s_add_u32 s23, s23, 8192
    s_cmp_ge_u32 s23, 81920
    s_cselect_b32 s24, 32768, 0
    s_sub_u32 s23, s23, s24
    s_add_u32 s17, s17, 1
    s_and_b32 s17, s17, 3
    s_mov_b32 s26, 8192
    s_cselect_b32 s26, s26, 0xffffa000
    v_mfma_f32_32x32x16_bf16 v[104:119], v[52:55], v[44:47], v[104:119]
    s_waitcnt lgkmcnt(0)
    v_mfma_f32_32x32x16_bf16 v[56:71], v[32:35], v[24:27], v[56:71]
    ds_read_b128 v[40:43], v19 offset:0
    ds_read_b128 v[44:47], v19 offset:4096
    ds_read_b64_tr_b16 v[48:49], v20 offset:2048
    s_mov_b32 m0, s21
    v_mfma_f32_32x32x16_bf16 v[72:87], v[36:39], v[24:27], v[72:87]
    ds_read_b64_tr_b16 v[50:51], v20 offset:2560
    ds_read_b64_tr_b16 v[52:53], v20 offset:6144
    ds_read_b64_tr_b16 v[54:55], v20 offset:6656
    buffer_load_dwordx4 v10, s[4:7], s18 offen offset:2048 lds
    v_mfma_f32_32x32x16_bf16 v[88:103], v[32:35], v[28:31], v[88:103]
    buffer_load_dwordx4 v11, s[4:7], s18 offen offset:3072 lds
    s_add_u32 s18, s18, 128
    s_add_u32 s21, s21, 16384
    s_cmp_ge_u32 s21, 49152
    s_cselect_b32 s24, 49152, 0
    s_sub_u32 s21, s21, s24
    s_add_u32 s27, s27, 1
    s_cmp_eq_u32 s27, 3
    s_mov_b32 s22, 16384
    s_cselect_b32 s22, 0xffff8000, s22
    s_cselect_b32 s27, 0, s27
    v_mfma_f32_32x32x16_bf16 v[104:119], v[36:39], v[28:31], v[104:119]
    v_add_u32 v20, s26, v20
    v_add_u32 v16, s22, v16
    v_add_u32 v17, s22, v17
    v_add_u32 v18, s22, v18
    v_add_u32 v19, s22, v19
.p2align 4
L_aq_loop:
    s_waitcnt vmcnt(8) lgkmcnt(0)
    s_barrier
    v_mfma_f32_32x32x16_bf16 v[56:71], v[48:51], v[40:43], v[56:71]
    ds_read_b128 v[24:27], v16 offset:0
    ds_read_b128 v[28:31], v16 offset:4096
    ds_read_b64_tr_b16 v[32:33], v20 offset:0
    s_mov_b32 m0, s23
    v_mfma_f32_32x32x16_bf16 v[72:87], v[52:55], v[40:43], v[72:87]
    ds_read_b64_tr_b16 v[34:35], v20 offset:512
    ds_read_b64_tr_b16 v[36:37], v20 offset:4096
    ds_read_b64_tr_b16 v[38:39], v20 offset:4608
    buffer_load_dwordx4 v12, s[8:11], s19 offen offset:0 lds
    v_mfma_f32_32x32x16_bf16 v[88:103], v[48:51], v[44:47], v[88:103]
    buffer_load_dwordx4 v13, s[8:11], s19 offen offset:1024 lds
    s_add_u32 s19, s19, s20
    s_add_u32 s23, s23, 8192
    s_cmp_ge_u32 s23, 81920
    s_cselect_b32 s24, 32768, 0
    s_sub_u32 s23, s23, s24
    s_add_u32 s17, s17, 1
    s_and_b32 s17, s17, 3
    s_mov_b32 s26, 8192
    s_cselect_b32 s26, s26, 0xffffa000
    v_mfma_f32_32x32x16_bf16 v[104:119], v[52:55], v[44:47], v[104:119]
    s_waitcnt lgkmcnt(0)
    v_mfma_f32_32x32x16_bf16 v[56:71], v[32:35], v[24:27], v[56:71]
    ds_read_b128 v[40:43], v17 offset:0
    ds_read_b128 v[44:47], v17 offset:4096
    ds_read_b64_tr_b16 v[48:49], v20 offset:2048
    s_mov_b32 m0, s21
    v_mfma_f32_32x32x16_bf16 v[72:87], v[36:39], v[24:27], v[72:87]
    ds_read_b64_tr_b16 v[50:51], v20 offset:2560
    ds_read_b64_tr_b16 v[52:53], v20 offset:6144
    ds_read_b64_tr_b16 v[54:55], v20 offset:6656
    buffer_load_dwordx4 v8, s[4:7], s18 offen offset:0 lds
    v_mfma_f32_32x32x16_bf16 v[88:103], v[32:35], v[28:31], v[88:103]
    buffer_load_dwordx4 v9, s[4:7], s18 offen offset:1024 lds
    v_mfma_f32_32x32x16_bf16 v[104:119], v[36:39], v[28:31], v[104:119]
    v_add_u32 v20, s26, v20
    s_waitcnt vmcnt(8) lgkmcnt(0)
    s_barrier
    v_mfma_f32_32x32x16_bf16 v[56:71], v[48:51], v[40:43], v[56:71]
    ds_read_b128 v[24:27], v18 offset:0
    ds_read_b128 v[28:31], v18 offset:4096
    ds_read_b64_tr_b16 v[32:33], v20 offset:0
    s_mov_b32 m0, s23
    v_mfma_f32_32x32x16_bf16 v[72:87], v[52:55], v[40:43], v[72:87]
    ds_read_b64_tr_b16 v[34:35], v20 offset:512
    ds_read_b64_tr_b16 v[36:37], v20 offset:4096
    ds_read_b64_tr_b16 v[38:39], v20 offset:4608
    buffer_load_dwordx4 v12, s[8:11], s19 offen offset:0 lds
    v_mfma_f32_32x32x16_bf16 v[88:103], v[48:51], v[44:47], v[88:103]
    buffer_load_dwordx4 v13, s[8:11], s19 offen offset:1024 lds
    s_add_u32 s19, s19, s20
    s_add_u32 s23, s23, 8192
    s_cmp_ge_u32 s23, 81920
    s_cselect_b32 s24, 32768, 0
    s_sub_u32 s23, s23, s24
    s_add_u32 s17, s17, 1
    s_and_b32 s17, s17, 3
    s_mov_b32 s26, 8192
    s_cselect_b32 s26, s26, 0xffffa000
    v_mfma_f32_32x32x16_bf16 v[104:119], v[52:55], v[44:47], v[104:119]
    s_waitcnt lgkmcnt(0)
    v_mfma_f32_32x32x16_bf16 v[56:71], v[32:35], v[24:27], v[56:71]
    ds_read_b128 v[40:43], v19 offset:0
    ds_read_b128 v[44:47], v19 offset:4096
    ds_read_b64_tr_b16 v[48:49], v20 offset:2048
    s_mov_b32 m0, s21
    v_mfma_f32_32x32x16_bf16 v[72:87], v[36:39], v[24:27], v[72:87]
    ds_read_b64_tr_b16 v[50:51], v20 offset:2560
    ds_read_b64_tr_b16 v[52:53], v20 offset:6144
    ds_read_b64_tr_b16 v[54:55], v20 offset:6656
    buffer_load_dwordx4 v10, s[4:7], s18 offen offset:2048 lds
    v_mfma_f32_32x32x16_bf16 v[88:103], v[32:35], v[28:31], v[88:103]
    buffer_load_dwordx4 v11, s[4:7], s18 offen offset:3072 lds
    s_add_u32 s18, s18, 128
    s_add_u32 s21, s21, 16384
    s_cmp_ge_u32 s21, 49152
    s_cselect_b32 s24, 49152, 0
    s_sub_u32 s21, s21, s24
    s_add_u32 s27, s27, 1
    s_cmp_eq_u32 s27, 3
    s_mov_b32 s22, 16384
    s_cselect_b32 s22, 0xffff8000, s22
    s_cselect_b32 s27, 0, s27
    v_mfma_f32_32x32x16_bf16 v[104:119], v[36:39], v[28:31], v[104:119]
    v_add_u32 v20, s26, v20
    v_add_u32 v16, s22, v16
    v_add_u32 v17, s22, v17
    v_add_u32 v18, s22, v18
    v_add_u32 v19, s22, v19
    s_add_u32 s29, s29, 1
    s_cmp_lt_u32 s29, 8
    s_cbranch_scc1 L_aq_loop
    v_mov_b32 v202, 0
    buffer_load_dwordx2 v[200:201], v202, s[48:51], 0 offen sc1
    s_waitcnt vmcnt(9) lgkmcnt(0)
    s_barrier
    v_mfma_f32_32x32x16_bf16 v[56:71], v[48:51], v[40:43], v[56:71]
    ds_read_b128 v[24:27], v16 offset:0
    ds_read_b128 v[28:31], v16 offset:4096
    ds_read_b64_tr_b16 v[32:33], v20 offset:0
    s_mov_b32 m0, s23
    v_mfma_f32_32x32x16_bf16 v[72:87], v[52:55], v[40:43], v[72:87]
    ds_read_b64_tr_b16 v[34:35], v20 offset:512
    ds_read_b64_tr_b16 v[36:37], v20 offset:4096
    ds_read_b64_tr_b16 v[38:39], v20 offset:4608
    buffer_load_dwordx4 v12, s[8:11], s19 offen offset:0 lds
    v_mfma_f32_32x32x16_bf16 v[88:103], v[48:51], v[44:47], v[88:103]
    buffer_load_dwordx4 v13, s[8:11], s19 offen offset:1024 lds
    s_add_u32 s19, s19, s20
    s_add_u32 s23, s23, 8192
    s_cmp_ge_u32 s23, 81920
    s_cselect_b32 s24, 32768, 0
    s_sub_u32 s23, s23, s24
    s_add_u32 s17, s17, 1
    s_and_b32 s17, s17, 3
    s_mov_b32 s26, 8192
    s_cselect_b32 s26, s26, 0xffffa000
    v_mfma_f32_32x32x16_bf16 v[104:119], v[52:55], v[44:47], v[104:119]
    s_waitcnt lgkmcnt(0)
    v_mfma_f32_32x32x16_bf16 v[56:71], v[32:35], v[24:27], v[56:71]
    ds_read_b128 v[40:43], v17 offset:0
    ds_read_b128 v[44:47], v17 offset:4096
    ds_read_b64_tr_b16 v[48:49], v20 offset:2048
    v_mfma_f32_32x32x16_bf16 v[72:87], v[36:39], v[24:27], v[72:87]
    ds_read_b64_tr_b16 v[50:51], v20 offset:2560
    ds_read_b64_tr_b16 v[52:53], v20 offset:6144
    ds_read_b64_tr_b16 v[54:55], v20 offset:6656
    v_mfma_f32_32x32x16_bf16 v[88:103], v[32:35], v[28:31], v[88:103]
    v_mfma_f32_32x32x16_bf16 v[104:119], v[36:39], v[28:31], v[104:119]
    v_add_u32 v20, s26, v20
    s_waitcnt vmcnt(7) lgkmcnt(0)
    s_barrier
    v_mfma_f32_32x32x16_bf16 v[56:71], v[48:51], v[40:43], v[56:71]
    ds_read_b128 v[24:27], v18 offset:0
    ds_read_b128 v[28:31], v18 offset:4096
    ds_read_b64_tr_b16 v[32:33], v20 offset:0
    v_mfma_f32_32x32x16_bf16 v[72:87], v[52:55], v[40:43], v[72:87]
    ds_read_b64_tr_b16 v[34:35], v20 offset:512
    ds_read_b64_tr_b16 v[36:37], v20 offset:4096
    ds_read_b64_tr_b16 v[38:39], v20 offset:4608
    v_mfma_f32_32x32x16_bf16 v[88:103], v[48:51], v[44:47], v[88:103]
    s_add_u32 s17, s17, 1
    s_and_b32 s17, s17, 3
    s_mov_b32 s26, 8192
    s_cselect_b32 s26, s26, 0xffffa000
    v_mfma_f32_32x32x16_bf16 v[104:119], v[52:55], v[44:47], v[104:119]
    s_waitcnt lgkmcnt(0)
    v_mfma_f32_32x32x16_bf16 v[56:71], v[32:35], v[24:27], v[56:71]
    ds_read_b128 v[40:43], v19 offset:0
    ds_read_b128 v[44:47], v19 offset:4096
    ds_read_b64_tr_b16 v[48:49], v20 offset:2048
    v_mfma_f32_32x32x16_bf16 v[72:87], v[36:39], v[24:27], v[72:87]
    ds_read_b64_tr_b16 v[50:51], v20 offset:2560
    ds_read_b64_tr_b16 v[52:53], v20 offset:6144
    ds_read_b64_tr_b16 v[54:55], v20 offset:6656
    v_mfma_f32_32x32x16_bf16 v[88:103], v[32:35], v[28:31], v[88:103]
    s_add_u32 s27, s27, 1
    s_cmp_eq_u32 s27, 3
    s_mov_b32 s22, 16384
    s_cselect_b32 s22, 0xffff8000, s22
    s_cselect_b32 s27, 0, s27
    v_mfma_f32_32x32x16_bf16 v[104:119], v[36:39], v[28:31], v[104:119]
    v_add_u32 v20, s26, v20
    v_add_u32 v16, s22, v16
    v_add_u32 v17, s22, v17
    v_add_u32 v18, s22, v18
    v_add_u32 v19, s22, v19
    s_waitcnt vmcnt(3) lgkmcnt(0)
    s_barrier
    v_mfma_f32_32x32x16_bf16 v[56:71], v[48:51], v[40:43], v[56:71]
    ds_read_b128 v[24:27], v16 offset:0
    ds_read_b128 v[28:31], v16 offset:4096
    ds_read_b64_tr_b16 v[32:33], v20 offset:0
    v_mfma_f32_32x32x16_bf16 v[72:87], v[52:55], v[40:43], v[72:87]
    ds_read_b64_tr_b16 v[34:35], v20 offset:512
    ds_read_b64_tr_b16 v[36:37], v20 offset:4096
    ds_read_b64_tr_b16 v[38:39], v20 offset:4608
    v_mfma_f32_32x32x16_bf16 v[88:103], v[48:51], v[44:47], v[88:103]
    s_add_u32 s17, s17, 1
    s_and_b32 s17, s17, 3
    s_mov_b32 s26, 8192
    s_cselect_b32 s26, s26, 0xffffa000
    v_mfma_f32_32x32x16_bf16 v[104:119], v[52:55], v[44:47], v[104:119]
    s_waitcnt lgkmcnt(0)
    v_mfma_f32_32x32x16_bf16 v[56:71], v[32:35], v[24:27], v[56:71]
    ds_read_b128 v[40:43], v17 offset:0
    ds_read_b128 v[44:47], v17 offset:4096
    ds_read_b64_tr_b16 v[48:49], v20 offset:2048
    v_mfma_f32_32x32x16_bf16 v[72:87], v[36:39], v[24:27], v[72:87]
    ds_read_b64_tr_b16 v[50:51], v20 offset:2560
    ds_read_b64_tr_b16 v[52:53], v20 offset:6144
    ds_read_b64_tr_b16 v[54:55], v20 offset:6656
    v_mfma_f32_32x32x16_bf16 v[88:103], v[32:35], v[28:31], v[88:103]
    v_mfma_f32_32x32x16_bf16 v[104:119], v[36:39], v[28:31], v[104:119]
    v_add_u32 v20, s26, v20
    s_waitcnt vmcnt(0) lgkmcnt(0)
    s_barrier
    v_mfma_f32_32x32x16_bf16 v[56:71], v[48:51], v[40:43], v[56:71]
    ds_read_b128 v[24:27], v18 offset:0
    ds_read_b128 v[28:31], v18 offset:4096
    ds_read_b64_tr_b16 v[32:33], v20 offset:0
    v_mfma_f32_32x32x16_bf16 v[72:87], v[52:55], v[40:43], v[72:87]
    ds_read_b64_tr_b16 v[34:35], v20 offset:512
    ds_read_b64_tr_b16 v[36:37], v20 offset:4096
    ds_read_b64_tr_b16 v[38:39], v20 offset:4608
    v_mfma_f32_32x32x16_bf16 v[88:103], v[48:51], v[44:47], v[88:103]
    s_add_u32 s17, s17, 1
    s_and_b32 s17, s17, 3
    s_mov_b32 s26, 8192
    s_cselect_b32 s26, s26, 0xffffa000
    v_mfma_f32_32x32x16_bf16 v[104:119], v[52:55], v[44:47], v[104:119]
    s_waitcnt lgkmcnt(0)
    v_mfma_f32_32x32x16_bf16 v[56:71], v[32:35], v[24:27], v[56:71]
    ds_read_b128 v[40:43], v19 offset:0
    ds_read_b128 v[44:47], v19 offset:4096
    ds_read_b64_tr_b16 v[48:49], v20 offset:2048
    v_mfma_f32_32x32x16_bf16 v[72:87], v[36:39], v[24:27], v[72:87]
    ds_read_b64_tr_b16 v[50:51], v20 offset:2560
    ds_read_b64_tr_b16 v[52:53], v20 offset:6144
    ds_read_b64_tr_b16 v[54:55], v20 offset:6656
    v_mfma_f32_32x32x16_bf16 v[88:103], v[32:35], v[28:31], v[88:103]
    s_add_u32 s27, s27, 1
    s_cmp_eq_u32 s27, 3
    s_mov_b32 s22, 16384
    s_cselect_b32 s22, 0xffff8000, s22
    s_cselect_b32 s27, 0, s27
    v_mfma_f32_32x32x16_bf16 v[104:119], v[36:39], v[28:31], v[104:119]
    v_add_u32 v20, s26, v20
    v_add_u32 v16, s22, v16
    v_add_u32 v17, s22, v17
    v_add_u32 v18, s22, v18
    v_add_u32 v19, s22, v19
    s_waitcnt lgkmcnt(0)
    v_mfma_f32_32x32x16_bf16 v[56:71], v[48:51], v[40:43], v[56:71]
    v_mfma_f32_32x32x16_bf16 v[72:87], v[52:55], v[40:43], v[72:87]
    v_mfma_f32_32x32x16_bf16 v[88:103], v[48:51], v[44:47], v[88:103]
    v_mfma_f32_32x32x16_bf16 v[104:119], v[52:55], v[44:47], v[104:119]
    s_nop 15
    s_mov_b32 s59, 0
L_a_e1n_nl:
    s_memrealtime s[56:57]
    v_readfirstlane_b32 s60, v200
    v_readfirstlane_b32 s61, v201
    s_nop 1
    s_min_u32 s58, s60, s61
    s_cmp_lg_u32 s58, 0
    s_cbranch_scc0 L_a_e1n_nr
    s_waitcnt lgkmcnt(0)
    s_sub_u32 s58, s56, s60
    s_add_u32 s58, s58, 500
    s_cmp_lt_u32 s58, 3000
    s_cbranch_scc1 L_a_e1n_nd
    s_cmp_ge_u32 s59, 64
    s_cbranch_scc1 L_a_e1n_nd
L_a_e1n_nr:
    s_waitcnt lgkmcnt(0)
    s_add_u32 s59, s59, 1
    s_cmp_ge_u32 s59, 0x20000
    s_cbranch_scc1 L_a_e1n_nd
    s_sleep 4
    buffer_load_dwordx2 v[200:201], v202, s[48:51], 0 offen sc1
    s_waitcnt vmcnt(0)
    s_branch L_a_e1n_nl
L_a_e1n_nd:
    s_cmp_ge_u32 s31, 5
    s_cbranch_scc1 L_a_k
    v_mul_f32 v56, s46, v56
    v_mul_f32 v57, s46, v57
    v_mul_f32 v58, s46, v58
    v_mul_f32 v59, s46, v59
    v_mul_f32 v60, s46, v60
    v_mul_f32 v61, s46, v61
    v_mul_f32 v62, s46, v62
    v_mul_f32 v63, s46, v63
    v_cvt_pk_bf16_f32 v24, v56, v57
    v_cvt_pk_bf16_f32 v25, v58, v59
    v_cvt_pk_bf16_f32 v26, v60, v61
    v_cvt_pk_bf16_f32 v27, v62, v63
    v_mul_f32 v88, s46, v88
    v_mul_f32 v89, s46, v89
    v_mul_f32 v90, s46, v90
    v_mul_f32 v91, s46, v91
    v_mul_f32 v92, s46, v92
    v_mul_f32 v93, s46, v93
    v_mul_f32 v94, s46, v94
    v_mul_f32 v95, s46, v95
    v_cvt_pk_bf16_f32 v28, v88, v89
    v_cvt_pk_bf16_f32 v29, v90, v91
    v_cvt_pk_bf16_f32 v30, v92, v93
    v_cvt_pk_bf16_f32 v31, v94, v95
    v_permlane32_swap_b32 v24, v26
    v_permlane32_swap_b32 v25, v27
    buffer_store_dwordx4 v[24:27], v204, s[12:15], s44 offen sc1 nt
    v_permlane32_swap_b32 v28, v30
    v_permlane32_swap_b32 v29, v31
    buffer_store_dwordx4 v[28:31], v204, s[12:15], s45 offen sc1 nt
    v_mul_f32 v64, s46, v64
    v_mul_f32 v65, s46, v65
    v_mul_f32 v66, s46, v66
    v_mul_f32 v67, s46, v67
    v_mul_f32 v68, s46, v68
    v_mul_f32 v69, s46, v69
    v_mul_f32 v70, s46, v70
    v_mul_f32 v71, s46, v71
    v_cvt_pk_bf16_f32 v32, v64, v65
    v_cvt_pk_bf16_f32 v33, v66, v67
    v_cvt_pk_bf16_f32 v34, v68, v69
    v_cvt_pk_bf16_f32 v35, v70, v71
    v_mul_f32 v96, s46, v96
    v_mul_f32 v97, s46, v97
    v_mul_f32 v98, s46, v98
    v_mul_f32 v99, s46, v99
    v_mul_f32 v100, s46, v100
    v_mul_f32 v101, s46, v101
    v_mul_f32 v102, s46, v102
    v_mul_f32 v103, s46, v103
    v_cvt_pk_bf16_f32 v36, v96, v97
    v_cvt_pk_bf16_f32 v37, v98, v99
    v_cvt_pk_bf16_f32 v38, v100, v101
    v_cvt_pk_bf16_f32 v39, v102, v103
    v_permlane32_swap_b32 v32, v34
    v_permlane32_swap_b32 v33, v35
    buffer_store_dwordx4 v[32:35], v205, s[12:15], s44 offen sc1 nt
    v_permlane32_swap_b32 v36, v38
    v_permlane32_swap_b32 v37, v39
    buffer_store_dwordx4 v[36:39], v205, s[12:15], s45 offen sc1 nt
    v_mul_f32 v72, s46, v72
    v_mul_f32 v73, s46, v73
    v_mul_f32 v74, s46, v74
    v_mul_f32 v75, s46, v75
    v_mul_f32 v76, s46, v76
    v_mul_f32 v77, s46, v77
    v_mul_f32 v78, s46, v78
    v_mul_f32 v79, s46, v79
    v_cvt_pk_bf16_f32 v40, v72, v73
    v_cvt_pk_bf16_f32 v41, v74, v75
    v_cvt_pk_bf16_f32 v42, v76, v77
    v_cvt_pk_bf16_f32 v43, v78, v79
    v_mul_f32 v104, s46, v104
    v_mul_f32 v105, s46, v105
    v_mul_f32 v106, s46, v106
    v_mul_f32 v107, s46, v107
    v_mul_f32 v108, s46, v108
    v_mul_f32 v109, s46, v109
    v_mul_f32 v110, s46, v110
    v_mul_f32 v111, s46, v111
    v_cvt_pk_bf16_f32 v44, v104, v105
    v_cvt_pk_bf16_f32 v45, v106, v107
    v_cvt_pk_bf16_f32 v46, v108, v109
    v_cvt_pk_bf16_f32 v47, v110, v111
    v_permlane32_swap_b32 v40, v42
    v_permlane32_swap_b32 v41, v43
    buffer_store_dwordx4 v[40:43], v206, s[12:15], s44 offen sc1 nt
    v_permlane32_swap_b32 v44, v46
    v_permlane32_swap_b32 v45, v47
    buffer_store_dwordx4 v[44:47], v206, s[12:15], s45 offen sc1 nt
    v_mul_f32 v80, s46, v80
    v_mul_f32 v81, s46, v81
    v_mul_f32 v82, s46, v82
    v_mul_f32 v83, s46, v83
    v_mul_f32 v84, s46, v84
    v_mul_f32 v85, s46, v85
    v_mul_f32 v86, s46, v86
    v_mul_f32 v87, s46, v87
    v_cvt_pk_bf16_f32 v48, v80, v81
    v_cvt_pk_bf16_f32 v49, v82, v83
    v_cvt_pk_bf16_f32 v50, v84, v85
    v_cvt_pk_bf16_f32 v51, v86, v87
    v_mul_f32 v112, s46, v112
    v_mul_f32 v113, s46, v113
    v_mul_f32 v114, s46, v114
    v_mul_f32 v115, s46, v115
    v_mul_f32 v116, s46, v116
    v_mul_f32 v117, s46, v117
    v_mul_f32 v118, s46, v118
    v_mul_f32 v119, s46, v119
    v_cvt_pk_bf16_f32 v52, v112, v113
    v_cvt_pk_bf16_f32 v53, v114, v115
    v_cvt_pk_bf16_f32 v54, v116, v117
    v_cvt_pk_bf16_f32 v55, v118, v119
    v_permlane32_swap_b32 v48, v50
    v_permlane32_swap_b32 v49, v51
    buffer_store_dwordx4 v[48:51], v207, s[12:15], s44 offen sc1 nt
    v_permlane32_swap_b32 v52, v54
    v_permlane32_swap_b32 v53, v55
    buffer_store_dwordx4 v[52:55], v207, s[12:15], s45 offen sc1 nt
    s_branch L_a_sig2
L_a_k:
    v_cvt_pk_bf16_f32 v24, v56, v57
    v_cvt_pk_bf16_f32 v25, v58, v59
    v_cvt_pk_bf16_f32 v26, v60, v61
    v_cvt_pk_bf16_f32 v27, v62, v63
    v_cvt_pk_bf16_f32 v28, v88, v89
    v_cvt_pk_bf16_f32 v29, v90, v91
    v_cvt_pk_bf16_f32 v30, v92, v93
    v_cvt_pk_bf16_f32 v31, v94, v95
    v_permlane32_swap_b32 v24, v26
    v_permlane32_swap_b32 v25, v27
    buffer_store_dwordx4 v[24:27], v204, s[12:15], s44 offen sc1 nt
    v_permlane32_swap_b32 v28, v30
    v_permlane32_swap_b32 v29, v31
    buffer_store_dwordx4 v[28:31], v204, s[12:15], s45 offen sc1 nt
    v_cvt_pk_bf16_f32 v32, v64, v65
    v_cvt_pk_bf16_f32 v33, v66, v67
    v_cvt_pk_bf16_f32 v34, v68, v69
    v_cvt_pk_bf16_f32 v35, v70, v71
    v_cvt_pk_bf16_f32 v36, v96, v97
    v_cvt_pk_bf16_f32 v37, v98, v99
    v_cvt_pk_bf16_f32 v38, v100, v101
    v_cvt_pk_bf16_f32 v39, v102, v103
    v_permlane32_swap_b32 v32, v34
    v_permlane32_swap_b32 v33, v35
    buffer_store_dwordx4 v[32:35], v205, s[12:15], s44 offen sc1 nt
    v_permlane32_swap_b32 v36, v38
    v_permlane32_swap_b32 v37, v39
    buffer_store_dwordx4 v[36:39], v205, s[12:15], s45 offen sc1 nt
    v_cvt_pk_bf16_f32 v40, v72, v73
    v_cvt_pk_bf16_f32 v41, v74, v75
    v_cvt_pk_bf16_f32 v42, v76, v77
    v_cvt_pk_bf16_f32 v43, v78, v79
    v_cvt_pk_bf16_f32 v44, v104, v105
    v_cvt_pk_bf16_f32 v45, v106, v107
    v_cvt_pk_bf16_f32 v46, v108, v109
    v_cvt_pk_bf16_f32 v47, v110, v111
    v_permlane32_swap_b32 v40, v42
    v_permlane32_swap_b32 v41, v43
    buffer_store_dwordx4 v[40:43], v206, s[12:15], s44 offen sc1 nt
    v_permlane32_swap_b32 v44, v46
    v_permlane32_swap_b32 v45, v47
    buffer_store_dwordx4 v[44:47], v206, s[12:15], s45 offen sc1 nt
    v_cvt_pk_bf16_f32 v48, v80, v81
    v_cvt_pk_bf16_f32 v49, v82, v83
    v_cvt_pk_bf16_f32 v50, v84, v85
    v_cvt_pk_bf16_f32 v51, v86, v87
    v_cvt_pk_bf16_f32 v52, v112, v113
    v_cvt_pk_bf16_f32 v53, v114, v115
    v_cvt_pk_bf16_f32 v54, v116, v117
    v_cvt_pk_bf16_f32 v55, v118, v119
    v_permlane32_swap_b32 v48, v50
    v_permlane32_swap_b32 v49, v51
    buffer_store_dwordx4 v[48:51], v207, s[12:15], s44 offen sc1 nt
    v_permlane32_swap_b32 v52, v54
    v_permlane32_swap_b32 v53, v55
    buffer_store_dwordx4 v[52:55], v207, s[12:15], s45 offen sc1 nt
    s_branch L_a_sig2
L_a_v:
    s_mov_b32 s17, 0
    s_mov_b32 s27, 0
    s_mov_b32 s29, 1
    s_waitcnt vmcnt(8) lgkmcnt(0)
    s_barrier
    ds_read_b128 v[24:27], v16 offset:0
    ds_read_b128 v[28:31], v16 offset:4096
    ds_read_b64_tr_b16 v[32:33], v20 offset:0
    s_mov_b32 m0, s23
    ds_read_b64_tr_b16 v[34:35], v20 offset:512
    ds_read_b64_tr_b16 v[36:37], v20 offset:4096
    ds_read_b64_tr_b16 v[38:39], v20 offset:4608
    buffer_load_dwordx4 v12, s[8:11], s19 offen offset:0 lds
    buffer_load_dwordx4 v13, s[8:11], s19 offen offset:1024 lds
    s_add_u32 s19, s19, s20
    s_add_u32 s23, s23, 8192
    s_cmp_ge_u32 s23, 81920
    s_cselect_b32 s24, 32768, 0
    s_sub_u32 s23, s23, s24
    s_add_u32 s17, s17, 1
    s_and_b32 s17, s17, 3
    s_mov_b32 s26, 8192
    s_cselect_b32 s26, s26, 0xffffa000
    s_waitcnt lgkmcnt(0)
    v_mfma_f32_32x32x16_bf16 v[56:71], v[24:27], v[32:35], 0
    ds_read_b128 v[40:43], v17 offset:0
    ds_read_b128 v[44:47], v17 offset:4096
    ds_read_b64_tr_b16 v[48:49], v20 offset:2048
    s_mov_b32 m0, s21
    v_mfma_f32_32x32x16_bf16 v[72:87], v[24:27], v[36:39], 0
    ds_read_b64_tr_b16 v[50:51], v20 offset:2560
    ds_read_b64_tr_b16 v[52:53], v20 offset:6144
    ds_read_b64_tr_b16 v[54:55], v20 offset:6656
    buffer_load_dwordx4 v8, s[4:7], s18 offen offset:0 lds
    v_mfma_f32_32x32x16_bf16 v[88:103], v[28:31], v[32:35], 0
    buffer_load_dwordx4 v9, s[4:7], s18 offen offset:1024 lds
    v_mfma_f32_32x32x16_bf16 v[104:119], v[28:31], v[36:39], 0
    v_add_u32 v20, s26, v20
    s_waitcnt vmcnt(8) lgkmcnt(0)
    s_barrier
    v_mfma_f32_32x32x16_bf16 v[56:71], v[40:43], v[48:51], v[56:71]
    ds_read_b128 v[24:27], v18 offset:0
    ds_read_b128 v[28:31], v18 offset:4096
    ds_read_b64_tr_b16 v[32:33], v20 offset:0
    s_mov_b32 m0, s23
    v_mfma_f32_32x32x16_bf16 v[72:87], v[40:43], v[52:55], v[72:87]
    ds_read_b64_tr_b16 v[34:35], v20 offset:512
    ds_read_b64_tr_b16 v[36:37], v20 offset:4096
    ds_read_b64_tr_b16 v[38:39], v20 offset:4608
    buffer_load_dwordx4 v12, s[8:11], s19 offen offset:0 lds
    v_mfma_f32_32x32x16_bf16 v[88:103], v[44:47], v[48:51], v[88:103]
    buffer_load_dwordx4 v13, s[8:11], s19 offen offset:1024 lds
    s_add_u32 s19, s19, s20
    s_add_u32 s23, s23, 8192
    s_cmp_ge_u32 s23, 81920
    s_cselect_b32 s24, 32768, 0
    s_sub_u32 s23, s23, s24
    s_add_u32 s17, s17, 1
    s_and_b32 s17, s17, 3
    s_mov_b32 s26, 8192
    s_cselect_b32 s26, s26, 0xffffa000
    v_mfma_f32_32x32x16_bf16 v[104:119], v[44:47], v[52:55], v[104:119]
    s_waitcnt lgkmcnt(0)
    v_mfma_f32_32x32x16_bf16 v[56:71], v[24:27], v[32:35], v[56:71]
    ds_read_b128 v[40:43], v19 offset:0
    ds_read_b128 v[44:47], v19 offset:4096
    ds_read_b64_tr_b16 v[48:49], v20 offset:2048
    s_mov_b32 m0, s21
    v_mfma_f32_32x32x16_bf16 v[72:87], v[24:27], v[36:39], v[72:87]
    ds_read_b64_tr_b16 v[50:51], v20 offset:2560
    ds_read_b64_tr_b16 v[52:53], v20 offset:6144
    ds_read_b64_tr_b16 v[54:55], v20 offset:6656
    buffer_load_dwordx4 v10, s[4:7], s18 offen offset:2048 lds
    v_mfma_f32_32x32x16_bf16 v[88:103], v[28:31], v[32:35], v[88:103]
    buffer_load_dwordx4 v11, s[4:7], s18 offen offset:3072 lds
    s_add_u32 s18, s18, 128
    s_add_u32 s21, s21, 16384
    s_cmp_ge_u32 s21, 49152
    s_cselect_b32 s24, 49152, 0
    s_sub_u32 s21, s21, s24
    s_add_u32 s27, s27, 1
    s_cmp_eq_u32 s27, 3
    s_mov_b32 s22, 16384
    s_cselect_b32 s22, 0xffff8000, s22
    s_cselect_b32 s27, 0, s27
    v_mfma_f32_32x32x16_bf16 v[104:119], v[28:31], v[36:39], v[104:119]
    v_add_u32 v20, s26, v20
    v_add_u32 v16, s22, v16
    v_add_u32 v17, s22, v17
    v_add_u32 v18, s22, v18
    v_add_u32 v19, s22, v19
.p2align 4
L_av_loop:
    s_waitcnt vmcnt(8) lgkmcnt(0)
    s_barrier
    v_mfma_f32_32x32x16_bf16 v[56:71], v[40:43], v[48:51], v[56:71]
    ds_read_b128 v[24:27], v16 offset:0
    ds_read_b128 v[28:31], v16 offset:4096
    ds_read_b64_tr_b16 v[32:33], v20 offset:0
    s_mov_b32 m0, s23
    v_mfma_f32_32x32x16_bf16 v[72:87], v[40:43], v[52:55], v[72:87]
    ds_read_b64_tr_b16 v[34:35], v20 offset:512
    ds_read_b64_tr_b16 v[36:37], v20 offset:4096
    ds_read_b64_tr_b16 v[38:39], v20 offset:4608
    buffer_load_dwordx4 v12, s[8:11], s19 offen offset:0 lds
    v_mfma_f32_32x32x16_bf16 v[88:103], v[44:47], v[48:51], v[88:103]
    buffer_load_dwordx4 v13, s[8:11], s19 offen offset:1024 lds
    s_add_u32 s19, s19, s20
    s_add_u32 s23, s23, 8192
    s_cmp_ge_u32 s23, 81920
    s_cselect_b32 s24, 32768, 0
    s_sub_u32 s23, s23, s24
    s_add_u32 s17, s17, 1
    s_and_b32 s17, s17, 3
    s_mov_b32 s26, 8192
    s_cselect_b32 s26, s26, 0xffffa000
    v_mfma_f32_32x32x16_bf16 v[104:119], v[44:47], v[52:55], v[104:119]
    s_waitcnt lgkmcnt(0)
    v_mfma_f32_32x32x16_bf16 v[56:71], v[24:27], v[32:35], v[56:71]
    ds_read_b128 v[40:43], v17 offset:0
    ds_read_b128 v[44:47], v17 offset:4096
    ds_read_b64_tr_b16 v[48:49], v20 offset:2048
    s_mov_b32 m0, s21
    v_mfma_f32_32x32x16_bf16 v[72:87], v[24:27], v[36:39], v[72:87]
    ds_read_b64_tr_b16 v[50:51], v20 offset:2560
    ds_read_b64_tr_b16 v[52:53], v20 offset:6144
    ds_read_b64_tr_b16 v[54:55], v20 offset:6656
    buffer_load_dwordx4 v8, s[4:7], s18 offen offset:0 lds
    v_mfma_f32_32x32x16_bf16 v[88:103], v[28:31], v[32:35], v[88:103]
    buffer_load_dwordx4 v9, s[4:7], s18 offen offset:1024 lds
    v_mfma_f32_32x32x16_bf16 v[104:119], v[28:31], v[36:39], v[104:119]
    v_add_u32 v20, s26, v20
    s_waitcnt vmcnt(8) lgkmcnt(0)
    s_barrier
    v_mfma_f32_32x32x16_bf16 v[56:71], v[40:43], v[48:51], v[56:71]
    ds_read_b128 v[24:27], v18 offset:0
    ds_read_b128 v[28:31], v18 offset:4096
    ds_read_b64_tr_b16 v[32:33], v20 offset:0
    s_mov_b32 m0, s23
    v_mfma_f32_32x32x16_bf16 v[72:87], v[40:43], v[52:55], v[72:87]
    ds_read_b64_tr_b16 v[34:35], v20 offset:512
    ds_read_b64_tr_b16 v[36:37], v20 offset:4096
    ds_read_b64_tr_b16 v[38:39], v20 offset:4608
    buffer_load_dwordx4 v12, s[8:11], s19 offen offset:0 lds
    v_mfma_f32_32x32x16_bf16 v[88:103], v[44:47], v[48:51], v[88:103]
    buffer_load_dwordx4 v13, s[8:11], s19 offen offset:1024 lds
    s_add_u32 s19, s19, s20
    s_add_u32 s23, s23, 8192
    s_cmp_ge_u32 s23, 81920
    s_cselect_b32 s24, 32768, 0
    s_sub_u32 s23, s23, s24
    s_add_u32 s17, s17, 1
    s_and_b32 s17, s17, 3
    s_mov_b32 s26, 8192
    s_cselect_b32 s26, s26, 0xffffa000
    v_mfma_f32_32x32x16_bf16 v[104:119], v[44:47], v[52:55], v[104:119]
    s_waitcnt lgkmcnt(0)
    v_mfma_f32_32x32x16_bf16 v[56:71], v[24:27], v[32:35], v[56:71]
    ds_read_b128 v[40:43], v19 offset:0
    ds_read_b128 v[44:47], v19 offset:4096
    ds_read_b64_tr_b16 v[48:49], v20 offset:2048
    s_mov_b32 m0, s21
    v_mfma_f32_32x32x16_bf16 v[72:87], v[24:27], v[36:39], v[72:87]
    ds_read_b64_tr_b16 v[50:51], v20 offset:2560
    ds_read_b64_tr_b16 v[52:53], v20 offset:6144
    ds_read_b64_tr_b16 v[54:55], v20 offset:6656
    buffer_load_dwordx4 v10, s[4:7], s18 offen offset:2048 lds
    v_mfma_f32_32x32x16_bf16 v[88:103], v[28:31], v[32:35], v[88:103]
    buffer_load_dwordx4 v11, s[4:7], s18 offen offset:3072 lds
    s_add_u32 s18, s18, 128
    s_add_u32 s21, s21, 16384
    s_cmp_ge_u32 s21, 49152
    s_cselect_b32 s24, 49152, 0
    s_sub_u32 s21, s21, s24
    s_add_u32 s27, s27, 1
    s_cmp_eq_u32 s27, 3
    s_mov_b32 s22, 16384
    s_cselect_b32 s22, 0xffff8000, s22
    s_cselect_b32 s27, 0, s27
    v_mfma_f32_32x32x16_bf16 v[104:119], v[28:31], v[36:39], v[104:119]
    v_add_u32 v20, s26, v20
    v_add_u32 v16, s22, v16
    v_add_u32 v17, s22, v17
    v_add_u32 v18, s22, v18
    v_add_u32 v19, s22, v19
    s_add_u32 s29, s29, 1
    s_cmp_lt_u32 s29, 8
    s_cbranch_scc1 L_av_loop
    v_mov_b32 v202, 0
    buffer_load_dwordx2 v[200:201], v202, s[48:51], 0 offen sc1
    s_waitcnt vmcnt(9) lgkmcnt(0)
    s_barrier
    v_mfma_f32_32x32x16_bf16 v[56:71], v[40:43], v[48:51], v[56:71]
    ds_read_b128 v[24:27], v16 offset:0
    ds_read_b128 v[28:31], v16 offset:4096
    ds_read_b64_tr_b16 v[32:33], v20 offset:0
    s_mov_b32 m0, s23
    v_mfma_f32_32x32x16_bf16 v[72:87], v[40:43], v[52:55], v[72:87]
    ds_read_b64_tr_b16 v[34:35], v20 offset:512
    ds_read_b64_tr_b16 v[36:37], v20 offset:4096
    ds_read_b64_tr_b16 v[38:39], v20 offset:4608
    buffer_load_dwordx4 v12, s[8:11], s19 offen offset:0 lds
    v_mfma_f32_32x32x16_bf16 v[88:103], v[44:47], v[48:51], v[88:103]
    buffer_load_dwordx4 v13, s[8:11], s19 offen offset:1024 lds
    s_add_u32 s19, s19, s20
    s_add_u32 s23, s23, 8192
    s_cmp_ge_u32 s23, 81920
    s_cselect_b32 s24, 32768, 0
    s_sub_u32 s23, s23, s24
    s_add_u32 s17, s17, 1
    s_and_b32 s17, s17, 3
    s_mov_b32 s26, 8192
    s_cselect_b32 s26, s26, 0xffffa000
    v_mfma_f32_32x32x16_bf16 v[104:119], v[44:47], v[52:55], v[104:119]
    s_waitcnt lgkmcnt(0)
    v_mfma_f32_32x32x16_bf16 v[56:71], v[24:27], v[32:35], v[56:71]
    ds_read_b128 v[40:43], v17 offset:0
    ds_read_b128 v[44:47], v17 offset:4096
    ds_read_b64_tr_b16 v[48:49], v20 offset:2048
    v_mfma_f32_32x32x16_bf16 v[72:87], v[24:27], v[36:39], v[72:87]
    ds_read_b64_tr_b16 v[50:51], v20 offset:2560
    ds_read_b64_tr_b16 v[52:53], v20 offset:6144
    ds_read_b64_tr_b16 v[54:55], v20 offset:6656
    v_mfma_f32_32x32x16_bf16 v[88:103], v[28:31], v[32:35], v[88:103]
    v_mfma_f32_32x32x16_bf16 v[104:119], v[28:31], v[36:39], v[104:119]
    v_add_u32 v20, s26, v20
    s_waitcnt vmcnt(7) lgkmcnt(0)
    s_barrier
    v_mfma_f32_32x32x16_bf16 v[56:71], v[40:43], v[48:51], v[56:71]
    ds_read_b128 v[24:27], v18 offset:0
    ds_read_b128 v[28:31], v18 offset:4096
    ds_read_b64_tr_b16 v[32:33], v20 offset:0
    v_mfma_f32_32x32x16_bf16 v[72:87], v[40:43], v[52:55], v[72:87]
    ds_read_b64_tr_b16 v[34:35], v20 offset:512
    ds_read_b64_tr_b16 v[36:37], v20 offset:4096
    ds_read_b64_tr_b16 v[38:39], v20 offset:4608
    v_mfma_f32_32x32x16_bf16 v[88:103], v[44:47], v[48:51], v[88:103]
    s_add_u32 s17, s17, 1
    s_and_b32 s17, s17, 3
    s_mov_b32 s26, 8192
    s_cselect_b32 s26, s26, 0xffffa000
    v_mfma_f32_32x32x16_bf16 v[104:119], v[44:47], v[52:55], v[104:119]
    s_waitcnt lgkmcnt(0)
    v_mfma_f32_32x32x16_bf16 v[56:71], v[24:27], v[32:35], v[56:71]
    ds_read_b128 v[40:43], v19 offset:0
    ds_read_b128 v[44:47], v19 offset:4096
    ds_read_b64_tr_b16 v[48:49], v20 offset:2048
    v_mfma_f32_32x32x16_bf16 v[72:87], v[24:27], v[36:39], v[72:87]
    ds_read_b64_tr_b16 v[50:51], v20 offset:2560
    ds_read_b64_tr_b16 v[52:53], v20 offset:6144
    ds_read_b64_tr_b16 v[54:55], v20 offset:6656
    v_mfma_f32_32x32x16_bf16 v[88:103], v[28:31], v[32:35], v[88:103]
    s_add_u32 s27, s27, 1
    s_cmp_eq_u32 s27, 3
    s_mov_b32 s22, 16384
    s_cselect_b32 s22, 0xffff8000, s22
    s_cselect_b32 s27, 0, s27
    v_mfma_f32_32x32x16_bf16 v[104:119], v[28:31], v[36:39], v[104:119]
    v_add_u32 v20, s26, v20
    v_add_u32 v16, s22, v16
    v_add_u32 v17, s22, v17
    v_add_u32 v18, s22, v18
    v_add_u32 v19, s22, v19
    s_waitcnt vmcnt(3) lgkmcnt(0)
    s_barrier
    v_mfma_f32_32x32x16_bf16 v[56:71], v[40:43], v[48:51], v[56:71]
    ds_read_b128 v[24:27], v16 offset:0
    ds_read_b128 v[28:31], v16 offset:4096
    ds_read_b64_tr_b16 v[32:33], v20 offset:0
    v_mfma_f32_32x32x16_bf16 v[72:87], v[40:43], v[52:55], v[72:87]
    ds_read_b64_tr_b16 v[34:35], v20 offset:512
    ds_read_b64_tr_b16 v[36:37], v20 offset:4096
    ds_read_b64_tr_b16 v[38:39], v20 offset:4608
    v_mfma_f32_32x32x16_bf16 v[88:103], v[44:47], v[48:51], v[88:103]
    s_add_u32 s17, s17, 1
    s_and_b32 s17, s17, 3
    s_mov_b32 s26, 8192
    s_cselect_b32 s26, s26, 0xffffa000
    v_mfma_f32_32x32x16_bf16 v[104:119], v[44:47], v[52:55], v[104:119]
    s_waitcnt lgkmcnt(0)
    v_mfma_f32_32x32x16_bf16 v[56:71], v[24:27], v[32:35], v[56:71]
    ds_read_b128 v[40:43], v17 offset:0
    ds_read_b128 v[44:47], v17 offset:4096
    ds_read_b64_tr_b16 v[48:49], v20 offset:2048
    v_mfma_f32_32x32x16_bf16 v[72:87], v[24:27], v[36:39], v[72:87]
    ds_read_b64_tr_b16 v[50:51], v20 offset:2560
    ds_read_b64_tr_b16 v[52:53], v20 offset:6144
    ds_read_b64_tr_b16 v[54:55], v20 offset:6656
    v_mfma_f32_32x32x16_bf16 v[88:103], v[28:31], v[32:35], v[88:103]
    v_mfma_f32_32x32x16_bf16 v[104:119], v[28:31], v[36:39], v[104:119]
    v_add_u32 v20, s26, v20
    s_waitcnt vmcnt(0) lgkmcnt(0)
    s_barrier
    v_mfma_f32_32x32x16_bf16 v[56:71], v[40:43], v[48:51], v[56:71]
    ds_read_b128 v[24:27], v18 offset:0
    ds_read_b128 v[28:31], v18 offset:4096
    ds_read_b64_tr_b16 v[32:33], v20 offset:0
    v_mfma_f32_32x32x16_bf16 v[72:87], v[40:43], v[52:55], v[72:87]
    ds_read_b64_tr_b16 v[34:35], v20 offset:512
    ds_read_b64_tr_b16 v[36:37], v20 offset:4096
    ds_read_b64_tr_b16 v[38:39], v20 offset:4608
    v_mfma_f32_32x32x16_bf16 v[88:103], v[44:47], v[48:51], v[88:103]
    s_add_u32 s17, s17, 1
    s_and_b32 s17, s17, 3
    s_mov_b32 s26, 8192
    s_cselect_b32 s26, s26, 0xffffa000
    v_mfma_f32_32x32x16_bf16 v[104:119], v[44:47], v[52:55], v[104:119]
    s_waitcnt lgkmcnt(0)
    v_mfma_f32_32x32x16_bf16 v[56:71], v[24:27], v[32:35], v[56:71]
    ds_read_b128 v[40:43], v19 offset:0
    ds_read_b128 v[44:47], v19 offset:4096
    ds_read_b64_tr_b16 v[48:49], v20 offset:2048
    v_mfma_f32_32x32x16_bf16 v[72:87], v[24:27], v[36:39], v[72:87]
    ds_read_b64_tr_b16 v[50:51], v20 offset:2560
    ds_read_b64_tr_b16 v[52:53], v20 offset:6144
    ds_read_b64_tr_b16 v[54:55], v20 offset:6656
    v_mfma_f32_32x32x16_bf16 v[88:103], v[28:31], v[32:35], v[88:103]
    s_add_u32 s27, s27, 1
    s_cmp_eq_u32 s27, 3
    s_mov_b32 s22, 16384
    s_cselect_b32 s22, 0xffff8000, s22
    s_cselect_b32 s27, 0, s27
    v_mfma_f32_32x32x16_bf16 v[104:119], v[28:31], v[36:39], v[104:119]
    v_add_u32 v20, s26, v20
    v_add_u32 v16, s22, v16
    v_add_u32 v17, s22, v17
    v_add_u32 v18, s22, v18
    v_add_u32 v19, s22, v19
    s_waitcnt lgkmcnt(0)
    v_mfma_f32_32x32x16_bf16 v[56:71], v[40:43], v[48:51], v[56:71]
    v_mfma_f32_32x32x16_bf16 v[72:87], v[40:43], v[52:55], v[72:87]
    v_mfma_f32_32x32x16_bf16 v[88:103], v[44:47], v[48:51], v[88:103]
    v_mfma_f32_32x32x16_bf16 v[104:119], v[44:47], v[52:55], v[104:119]
    s_nop 15
    s_mov_b32 s59, 0
L_a_e2n_nl:
    s_memrealtime s[56:57]
    v_readfirstlane_b32 s60, v200
    v_readfirstlane_b32 s61, v201
    s_nop 1
    s_min_u32 s58, s60, s61
    s_cmp_lg_u32 s58, 0
    s_cbranch_scc0 L_a_e2n_nr
    s_waitcnt lgkmcnt(0)
    s_sub_u32 s58, s56, s60
    s_add_u32 s58, s58, 500
    s_cmp_lt_u32 s58, 3000
    s_cbranch_scc1 L_a_e2n_nd
    s_cmp_ge_u32 s59, 64
    s_cbranch_scc1 L_a_e2n_nd
L_a_e2n_nr:
    s_waitcnt lgkmcnt(0)
    s_add_u32 s59, s59, 1
    s_cmp_ge_u32 s59, 0x20000
    s_cbranch_scc1 L_a_e2n_nd
    s_sleep 4
    buffer_load_dwordx2 v[200:201], v202, s[48:51], 0 offen sc1
    s_waitcnt vmcnt(0)
    s_branch L_a_e2n_nl
L_a_e2n_nd:
    s_sub_u32 s36, s31, 10
    s_lshl_b32 s36, s36, 7
    s_and_b32 s47, s16, 1
    s_lshl_b32 s47, s47, 5
    s_add_u32 s36, s36, s47
    s_mul_i32 s42, s35, 81920
    s_add_u32 s42, s42, 2662400
    s_add_u32 s43, s42, 81920
    v_and_b32 v24, 31, v1
    v_add_u32 v24, s36, v24
    v_lshrrev_b32 v27, 5, v1
    v_mul_u32_u24 v27, 10240, v27
    v_lshl_add_u32 v27, v24, 4, v27
    v_add_u32 v28, 20480, v27
    v_cvt_pk_bf16_f32 v32, v56, v57
    v_cvt_pk_bf16_f32 v33, v58, v59
    v_cvt_pk_bf16_f32 v34, v60, v61
    v_cvt_pk_bf16_f32 v35, v62, v63
    buffer_store_dwordx4 v[32:35], v27, s[12:15], s42 offen offset:0 sc1 nt
    v_cvt_pk_bf16_f32 v36, v64, v65
    v_cvt_pk_bf16_f32 v37, v66, v67
    v_cvt_pk_bf16_f32 v38, v68, v69
    v_cvt_pk_bf16_f32 v39, v70, v71
    buffer_store_dwordx4 v[36:39], v28, s[12:15], s42 offen offset:0 sc1 nt
    v_cvt_pk_bf16_f32 v40, v88, v89
    v_cvt_pk_bf16_f32 v41, v90, v91
    v_cvt_pk_bf16_f32 v42, v92, v93
    v_cvt_pk_bf16_f32 v43, v94, v95
    buffer_store_dwordx4 v[40:43], v27, s[12:15], s43 offen offset:0 sc1 nt
    v_cvt_pk_bf16_f32 v44, v96, v97
    v_cvt_pk_bf16_f32 v45, v98, v99
    v_cvt_pk_bf16_f32 v46, v100, v101
    v_cvt_pk_bf16_f32 v47, v102, v103
    buffer_store_dwordx4 v[44:47], v28, s[12:15], s43 offen offset:0 sc1 nt
    v_cvt_pk_bf16_f32 v32, v72, v73
    v_cvt_pk_bf16_f32 v33, v74, v75
    v_cvt_pk_bf16_f32 v34, v76, v77
    v_cvt_pk_bf16_f32 v35, v78, v79
    buffer_store_dwordx4 v[32:35], v27, s[12:15], s42 offen offset:1024 sc1 nt
    v_cvt_pk_bf16_f32 v36, v80, v81
    v_cvt_pk_bf16_f32 v37, v82, v83
    v_cvt_pk_bf16_f32 v38, v84, v85
    v_cvt_pk_bf16_f32 v39, v86, v87
    buffer_store_dwordx4 v[36:39], v28, s[12:15], s42 offen offset:1024 sc1 nt
    v_cvt_pk_bf16_f32 v40, v104, v105
    v_cvt_pk_bf16_f32 v41, v106, v107
    v_cvt_pk_bf16_f32 v42, v108, v109
    v_cvt_pk_bf16_f32 v43, v110, v111
    buffer_store_dwordx4 v[40:43], v27, s[12:15], s43 offen offset:1024 sc1 nt
    v_cvt_pk_bf16_f32 v44, v112, v113
    v_cvt_pk_bf16_f32 v45, v114, v115
    v_cvt_pk_bf16_f32 v46, v116, v117
    v_cvt_pk_bf16_f32 v47, v118, v119
    buffer_store_dwordx4 v[44:47], v28, s[12:15], s43 offen offset:1024 sc1 nt
L_a_sig2:
    s_waitcnt vmcnt(0)
    s_branch L_a_sig3
L_a_sig:
    s_waitcnt vmcnt(0)
L_a_sig3:
    s_lshl_b32 s42, s31, 4
    s_add_u32 s42, s42, s30
    s_lshl_b32 s42, s42, 3
    s_add_u32 s42, s42, 26214400
    v_and_b32 v1, 63, v0
    s_cmp_ge_u32 s31, 10
    s_cselect_b32 s43, 10, 0
    s_cmp_ge_u32 s31, 5
    s_cselect_b32 s44, 5, 0
    s_max_u32 s43, s43, s44
    s_sub_u32 s43, s31, s43
    s_lshl_b32 s43, s43, 7
    s_mul_i32 s44, s43, 1639
    s_lshr_b32 s44, s44, 16
    s_add_u32 s43, s43, 127
    s_mul_i32 s45, s43, 1639
    s_lshr_b32 s45, s45, 16
    s_sub_u32 s45, s45, s44
    s_add_u32 s45, s45, 1
    s_cmp_eq_u32 s31, 15
    s_cselect_b32 s44, 0, s44
    s_cselect_b32 s45, 16, s45
    s_waitcnt vmcnt(0)
    s_barrier
    s_cmp_eq_u32 s16, 0
    s_cbranch_scc0 L_a_f_fs
    v_mov_b32 v4, s60
    v_mov_b32 v5, s61
    v_add_u32 v6, s44, v1
    v_mul_u32_u24 v6, 2048, v6
    s_mov_b64 s[58:59], exec
    s_bfm_b64 exec, s45, 0
    buffer_store_dwordx2 v[4:5], v6, s[12:15], s42 offen sc1
    s_mov_b64 exec, s[58:59]
L_a_f_fs:
    s_setprio 2
    s_and_b32 s30, s2, 7
    s_lshl_b32 s30, s30, 2
    s_bfe_u32 s31, s2, 0x20003
    s_add_u32 s30, s30, s31
    s_lshr_b32 s31, s2, 5
    v_and_b32 v1, 63, v0
    v_lshrrev_b32 v2, 6, v0
    s_nop 0
    v_readfirstlane_b32 s16, v2
    s_and_b32 s33, s30, 1
    s_lshr_b32 s34, s30, 1
    s_mul_i32 s35, s34, 2560
    s_lshl_b32 s36, s33, 10
    s_add_u32 s36, s36, s35
    v_lshlrev_b32 v2, 4, v1
    v_add_u32 v12, s36, v2
    s_add_u32 s36, s35, 1024
    v_add_u32 v3, s36, v2
    s_mul_i32 s36, s30, 320
    v_subrev_u32 v4, 32, v1
    v_max_i32 v4, 0, v4
    v_min_u32 v4, 83, v4
    v_mul_u32_u24 v5, 3121, v4
    v_lshrrev_b32 v5, 16, v5
    v_mul_u32_u24 v6, 21, v5
    v_sub_u32 v6, v4, v6
    v_min_u32 v6, 19, v6
    v_mul_u32_u24 v5, 10240, v5
    v_lshl_add_u32 v5, v6, 4, v5
    s_add_u32 s37, s36, 39936
    v_add_u32 v7, s37, v5
    v_cmp_gt_u32 vcc, 32, v1
    s_nop 1
    v_cndmask_b32 v13, v7, v3, vcc
    v_add_u32 v4, 32, v1
    v_max_i32 v4, 0, v4
    v_min_u32 v4, 83, v4
    v_mul_u32_u24 v5, 3121, v4
    v_lshrrev_b32 v5, 16, v5
    v_mul_u32_u24 v6, 21, v5
    v_sub_u32 v6, v4, v6
    v_min_u32 v6, 19, v6
    v_mul_u32_u24 v5, 10240, v5
    v_lshl_add_u32 v5, v6, 4, v5
    s_add_u32 s37, s36, 38912
    v_add_u32 v14, s37, v5
    s_mov_b32 s26, 0xffffffff
    s_mov_b32 s27, 0xffefffff
    s_mov_b32 s28, 0xbffffdff
    s_mov_b32 s29, 0x7ffff
    s_mul_i32 s36, s16, 24
    v_add_u32 v2, s36, v1
    v_lshrrev_b32 v3, 2, v2
    v_mul_u32_u24 v3, 3072, v3
    v_and_b32 v2, 3, v2
    v_mul_u32_u24 v2, 336, v2
    v_add3_u32 v2, v2, v3, 0
    v_add_u32 v2, 1856, v2
    v_mov_b32 v60, 0x3f803f80
    v_mov_b32 v61, 0x3f803f80
    v_mov_b32 v62, 0x3f803f80
    v_mov_b32 v63, 0x3f803f80
    s_mov_b64 exec, 0xffffff
    ds_write_b128 v2, v[60:63]
    s_mov_b64 exec, -1
    v_mov_b32 v64, 0
    v_mov_b32 v65, 0
    v_mov_b32 v66, 0
    v_mov_b32 v67, 0
    v_mul_u32_u24 v2, 3072, v1
    v_add_u32 v2, 2880, v2
    s_mov_b64 exec, 0xffffff
    ds_write_b128 v2, v[64:67]
    s_mov_b64 exec, -1
    s_mul_i32 s36, s34, 40
    s_lshr_b32 s37, s36, 7
    s_add_u32 s36, s36, 39
    s_lshr_b32 s38, s36, 7
    v_bfe_u32 v92, v1, 4, 1
    v_mov_b32 v93, s37
    v_mov_b32 v94, s38
    v_cmp_eq_u32 vcc, 1, v92
    s_nop 1
    v_cndmask_b32 v93, v93, v94, vcc
    v_lshrrev_b32 v94, 5, v1
    v_mul_u32_u24 v94, 5, v94
    v_add3_u32 v95, v93, v94, 5
    v_lshlrev_b32 v95, 7, v95
    v_and_b32 v94, 15, v1
    v_lshl_add_u32 v95, v94, 3, v95
    v_lshlrev_b32 v96, 7, v93
    v_and_b32 v94, 1, v1
    s_lshl_b32 s36, s31, 1
    v_add_u32 v94, s36, v94
    v_lshl_add_u32 v96, v94, 3, v96
    v_lshlrev_b32 v94, 3, v94
    v_add_u32 v94, 1920, v94
    v_cmp_lt_u32 vcc, 31, v1
    s_nop 1
    v_cndmask_b32 v96, v96, v94, vcc
    s_lshl_b32 s36, s34, 11
    s_add_u32 s36, s36, 26214400
    s_cmp_eq_u32 s16, 0
    s_cbranch_scc0 L_at_q_fd
    s_mov_b32 s59, 0
L_at_q_fw:
    buffer_load_dwordx2 v[76:77], v95, s[12:15], s36 offen sc1
    buffer_load_dwordx2 v[78:79], v96, s[12:15], s36 offen sc1
    s_waitcnt vmcnt(0)
    v_cmp_ne_u64 vcc, s[60:61], v[76:77]
    s_mov_b64 s[56:57], vcc
    v_cmp_ne_u64 vcc, s[60:61], v[78:79]
    s_or_b64 s[56:57], s[56:57], vcc
    s_cmp_eq_u64 s[56:57], 0
    s_cbranch_scc1 L_at_q_fd
    s_add_u32 s59, s59, 1
    s_cmp_ge_u32 s59, 0x20000
    s_cbranch_scc1 L_at_q_fd
    s_sleep 2
    s_branch L_at_q_fw
L_at_q_fd:
    s_barrier
    s_mov_b32 s52, s12
    s_mov_b32 s53, s13
    s_mov_b32 s54, 268435456
    s_mov_b32 s55, 0x20000
    s_mul_i32 s20, s16, 163840
    s_add_u32 s18, s20, 2621440
    s_mul_i32 s19, s16, 6144
    s_mov_b32 m0, s19
    s_nop 0
    buffer_load_dwordx4 v12, s[52:55], s18 offen offset:0 sc1 lds
    s_mov_b64 exec, s[26:27]
    buffer_load_dwordx4 v13, s[52:55], s18 offen offset:1024 sc1 lds
    s_mov_b64 exec, -1
    s_mov_b64 exec, s[28:29]
    buffer_load_dwordx4 v14, s[52:55], s18 offen offset:2048 sc1 lds
    s_mov_b64 exec, -1
    s_add_u32 m0, s19, 3072
    s_add_u32 s20, s18, 81920
    s_nop 0
    buffer_load_dwordx4 v12, s[52:55], s20 offen offset:0 sc1 lds
    s_mov_b64 exec, s[26:27]
    buffer_load_dwordx4 v13, s[52:55], s20 offen offset:1024 sc1 lds
    s_mov_b64 exec, -1
    s_mov_b64 exec, s[28:29]
    buffer_load_dwordx4 v14, s[52:55], s20 offen offset:2048 sc1 lds
    s_mov_b64 exec, -1
    s_add_u32 s18, s18, 655360
    s_add_u32 s19, s19, 24576
    s_cmp_ge_u32 s19, 73728
    s_cselect_b32 s21, 73728, 0
    s_sub_u32 s19, s19, s21
    s_lshl_b32 s32, s31, 3
    s_lshl_b32 s36, s16, 1
    s_add_u32 s32, s32, s36
    s_lshl_b32 s36, s32, 4
    s_add_u32 s36, s36, s34
    s_mul_i32 s36, s36, 2560
    s_lshl_b32 s37, s33, 10
    s_add_u32 s37, s37, s36
    s_lshl_b32 s38, s33, 3
    s_add_u32 s38, s38, s36
    v_lshlrev_b32 v4, 4, v1
    v_and_b32 v2, 31, v1
    v_lshlrev_b32 v3, 4, v2
    s_add_u32 s39, s37, 0
    buffer_load_dwordx4 v[20:23], v4, s[12:15], s39 offen sc1
    s_add_u32 s39, s38, 2048
    buffer_load_dwordx2 v[28:29], v3, s[12:15], s39 offen sc1
    s_add_u32 s39, s37, 40960
    buffer_load_dwordx4 v[24:27], v4, s[12:15], s39 offen sc1
    s_add_u32 s39, s38, 43008
    buffer_load_dwordx2 v[30:31], v3, s[12:15], s39 offen sc1
    s_lshl_b32 s36, s32, 7
    s_add_u32 s36, s36, 7864320
    v_lshlrev_b32 v4, 2, v2
    buffer_load_dword v15, v4, s[12:15], s36 offen offset:0 sc1
    buffer_load_dword v16, v4, s[12:15], s36 offen offset:128 sc1
    s_mov_b32 m0, s19
    s_nop 0
    buffer_load_dwordx4 v12, s[52:55], s18 offen offset:0 sc1 lds
    s_mov_b64 exec, s[26:27]
    buffer_load_dwordx4 v13, s[52:55], s18 offen offset:1024 sc1 lds
    s_mov_b64 exec, -1
    s_mov_b64 exec, s[28:29]
    buffer_load_dwordx4 v14, s[52:55], s18 offen offset:2048 sc1 lds
    s_mov_b64 exec, -1
    s_add_u32 m0, s19, 3072
    s_add_u32 s20, s18, 81920
    s_nop 0
    buffer_load_dwordx4 v12, s[52:55], s20 offen offset:0 sc1 lds
    s_mov_b64 exec, s[26:27]
    buffer_load_dwordx4 v13, s[52:55], s20 offen offset:1024 sc1 lds
    s_mov_b64 exec, -1
    s_mov_b64 exec, s[28:29]
    buffer_load_dwordx4 v14, s[52:55], s20 offen offset:2048 sc1 lds
    s_mov_b64 exec, -1
    s_add_u32 s18, s18, 655360
    s_add_u32 s19, s19, 24576
    s_cmp_ge_u32 s19, 73728
    s_cselect_b32 s21, 73728, 0
    s_sub_u32 s19, s19, s21
    v_lshlrev_b32 v8, 4, v1
    v_and_b32 v2, 31, v1
    v_lshlrev_b32 v3, 4, v2
    s_lshl_b32 s36, s33, 3
    s_add_u32 s36, s36, 1024
    v_add_u32 v9, s36, v3
    v_lshrrev_b32 v5, 5, v1
    v_mul_u32_u24 v6, 336, v5
    v_add3_u32 v6, v6, v3, 0
    v_add_u32 v10, 1536, v6
    v_add_u32 v11, 672, v10
    v_mov_b32 v6, 2880
    v_cmp_lt_u32 vcc, 20, v2
    s_nop 1
    v_cndmask_b32 v10, v10, v6, vcc
    v_cndmask_b32 v11, v11, v6, vcc
    v_cmp_lt_u32 vcc, 31, v1
    s_nop 1
    v_cndmask_b32 v9, v9, v6, vcc
    v_and_b32 v84, 15, v1
    v_lshlrev_b32 v84, 4, v84
    v_bfe_u32 v85, v1, 4, 1
    s_mov_b32 s42, 75776
    v_mad_u32_u24 v84, v85, s42, v84
    v_lshrrev_b32 v85, 5, v1
    s_mul_i32 s43, s30, 5
    s_lshl_b32 s44, s32, 1
    s_mul_i32 s44, s44, 75776
    s_add_u32 s44, s44, 7985152
    s_add_u32 s45, s44, 151552
    v_add_u32 v86, s43, v85
    v_lshrrev_b32 v87, 3, v86
    v_lshlrev_b32 v87, 10, v87
    v_and_b32 v88, 3, v86
    v_lshl_add_u32 v87, v88, 8, v87
    v_bfe_u32 v88, v86, 2, 1
    v_lshl_add_u32 v87, v88, 3, v87
    v_add_u32 v17, v87, v84
    v_add_u32 v86, s43, v85
    v_add_u32 v86, 2, v86
    v_lshrrev_b32 v87, 3, v86
    v_lshlrev_b32 v87, 10, v87
    v_and_b32 v88, 3, v86
    v_lshl_add_u32 v87, v88, 8, v87
    v_bfe_u32 v88, v86, 2, 1
    v_lshl_add_u32 v87, v88, 3, v87
    v_add_u32 v18, v87, v84
    v_add_u32 v86, s43, v85
    v_add_u32 v86, 4, v86
    v_lshrrev_b32 v87, 3, v86
    v_lshlrev_b32 v87, 10, v87
    v_and_b32 v88, 3, v86
    v_lshl_add_u32 v87, v88, 8, v87
    v_bfe_u32 v88, v86, 2, 1
    v_lshl_add_u32 v87, v88, 3, v87
    v_add_u32 v19, v87, v84
    v_mov_b32 v108, 0
    v_mov_b32 v109, 0
    v_mov_b32 v110, 0
    v_mov_b32 v111, 0
    v_mov_b32 v112, 0
    v_mov_b32 v113, 0
    v_mov_b32 v114, 0
    v_mov_b32 v115, 0
    v_mov_b32 v116, 0
    v_mov_b32 v117, 0
    v_mov_b32 v118, 0
    v_mov_b32 v119, 0
    v_mov_b32 v120, 0
    v_mov_b32 v121, 0
    v_mov_b32 v122, 0
    v_mov_b32 v123, 0
    v_mov_b32 v124, 0
    v_mov_b32 v125, 0
    v_mov_b32 v126, 0
    v_mov_b32 v127, 0
    v_mov_b32 v128, 0
    v_mov_b32 v129, 0
    v_mov_b32 v130, 0
    v_mov_b32 v131, 0
    v_mov_b32 v132, 0
    v_mov_b32 v133, 0
    v_mov_b32 v134, 0
    v_mov_b32 v135, 0
    v_mov_b32 v136, 0
    v_mov_b32 v137, 0
    v_mov_b32 v138, 0
    v_mov_b32 v139, 0
    v_mov_b32 v60, 0
    v_mov_b32 v61, 0
    v_mov_b32 v62, 0
    v_mov_b32 v63, 0
    v_mov_b32 v64, 0
    v_mov_b32 v65, 0
    v_mov_b32 v66, 0
    v_mov_b32 v67, 0
    v_mov_b32 v68, 0
    v_mov_b32 v69, 0
    v_mov_b32 v70, 0
    v_mov_b32 v71, 0
    v_mov_b32 v72, 0
    v_mov_b32 v73, 0
    v_mov_b32 v74, 0
    v_mov_b32 v75, 0
    v_mov_b32 v44, 0
    v_mov_b32 v45, 0
    v_mov_b32 v46, 0
    v_mov_b32 v47, 0
    v_mov_b32 v48, 0
    v_mov_b32 v49, 0
    v_mov_b32 v50, 0
    v_mov_b32 v51, 0
    v_mov_b32 v52, 0
    v_mov_b32 v53, 0
    v_mov_b32 v54, 0
    v_mov_b32 v55, 0
    v_mov_b32 v56, 0
    v_mov_b32 v57, 0
    v_mov_b32 v58, 0
    v_mov_b32 v59, 0
    s_waitcnt vmcnt(6) lgkmcnt(0)
    v_cmp_gt_u32 vcc, 32, v1
    s_nop 1
    v_cndmask_b32 v28, 0, v28, vcc
    v_cndmask_b32 v29, 0, v29, vcc
    v_cndmask_b32 v30, 0, v30, vcc
    v_cndmask_b32 v31, 0, v31, vcc
    s_barrier
    ds_read_b128 v[32:35], v8
    ds_read_b64 v[40:41], v9
    s_waitcnt lgkmcnt(0)
    v_mfma_f32_32x32x16_bf16 v[76:91], v[32:35], v[20:23], 0
    v_mfma_f32_32x32x8_bf16 v[76:91], v[40:41], v[28:29], v[76:91]
    s_nop 15
    s_mov_b32 s17, 0
    s_mov_b32 s24, 0
    s_mov_b32 s25, 24576
.p2align 4
L_at_loop:
    v_mfma_f32_32x32x16_bf16 v[92:107], v[32:35], v[24:27], 0
    ds_read_b128 v[36:39], v8 offset:3072
    v_exp_f32 v76, v76
    v_exp_f32 v77, v77
    v_exp_f32 v78, v78
    v_exp_f32 v79, v79
    v_cvt_pk_bf16_f32 v60, v76, v77
    v_exp_f32 v80, v80
    v_mfma_f32_32x32x8_bf16 v[92:107], v[40:41], v[30:31], v[92:107]
    ds_read_b64 v[42:43], v9 offset:3072
    v_exp_f32 v81, v81
    v_cvt_pk_bf16_f32 v61, v78, v79
    v_exp_f32 v82, v82
    v_exp_f32 v83, v83
    v_cvt_pk_bf16_f32 v62, v80, v81
    v_exp_f32 v84, v84
    v_mfma_f32_32x32x16_bf16 v[124:139], v[52:55], v[68:71], v[124:139]
    ds_read_b128 v[44:47], v10 offset:0
    v_exp_f32 v85, v85
    v_cvt_pk_bf16_f32 v63, v82, v83
    v_exp_f32 v86, v86
    v_exp_f32 v87, v87
    v_cvt_pk_bf16_f32 v64, v84, v85
    v_exp_f32 v88, v88
    v_mfma_f32_32x32x16_bf16 v[124:139], v[56:59], v[72:75], v[124:139]
    ds_read_b128 v[48:51], v11 offset:0
    s_waitcnt lgkmcnt(2)
    v_exp_f32 v89, v89
    v_cvt_pk_bf16_f32 v65, v86, v87
    v_exp_f32 v90, v90
    v_exp_f32 v91, v91
    v_cvt_pk_bf16_f32 v66, v88, v89
    v_cvt_pk_bf16_f32 v67, v90, v91
    v_mfma_f32_32x32x16_bf16 v[76:91], v[36:39], v[20:23], 0
    s_mov_b32 m0, s19
    v_exp_f32 v92, v92
    v_exp_f32 v93, v93
    v_exp_f32 v94, v94
    v_exp_f32 v95, v95
    v_cvt_pk_bf16_f32 v68, v92, v93
    v_exp_f32 v96, v96
    v_mfma_f32_32x32x8_bf16 v[76:91], v[42:43], v[28:29], v[76:91]
    s_waitcnt lgkmcnt(0)
    v_exp_f32 v97, v97
    v_cvt_pk_bf16_f32 v69, v94, v95
    v_exp_f32 v98, v98
    v_exp_f32 v99, v99
    v_cvt_pk_bf16_f32 v70, v96, v97
    v_exp_f32 v100, v100
    v_mfma_f32_32x32x16_bf16 v[108:123], v[44:47], v[60:63], v[108:123]
    buffer_load_dwordx4 v12, s[52:55], s18 offen offset:0 sc1 lds
    v_exp_f32 v101, v101
    v_cvt_pk_bf16_f32 v71, v98, v99
    v_exp_f32 v102, v102
    v_exp_f32 v103, v103
    v_cvt_pk_bf16_f32 v72, v100, v101
    v_exp_f32 v104, v104
    v_mfma_f32_32x32x16_bf16 v[108:123], v[48:51], v[64:67], v[108:123]
    s_mov_b64 exec, s[26:27]
    buffer_load_dwordx4 v13, s[52:55], s18 offen offset:1024 sc1 lds
    s_mov_b64 exec, -1
    v_exp_f32 v105, v105
    v_cvt_pk_bf16_f32 v73, v102, v103
    v_exp_f32 v106, v106
    v_exp_f32 v107, v107
    v_cvt_pk_bf16_f32 v74, v104, v105
    v_cvt_pk_bf16_f32 v75, v106, v107
    v_mfma_f32_32x32x16_bf16 v[92:107], v[36:39], v[24:27], 0
    ds_read_b128 v[32:35], v8 offset:6144
    v_exp_f32 v76, v76
    v_exp_f32 v77, v77
    v_exp_f32 v78, v78
    v_exp_f32 v79, v79
    v_cvt_pk_bf16_f32 v60, v76, v77
    v_exp_f32 v80, v80
    v_mfma_f32_32x32x8_bf16 v[92:107], v[42:43], v[30:31], v[92:107]
    ds_read_b64 v[40:41], v9 offset:6144
    v_exp_f32 v81, v81
    v_cvt_pk_bf16_f32 v61, v78, v79
    v_exp_f32 v82, v82
    v_exp_f32 v83, v83
    v_cvt_pk_bf16_f32 v62, v80, v81
    v_exp_f32 v84, v84
    v_mfma_f32_32x32x16_bf16 v[124:139], v[44:47], v[68:71], v[124:139]
    ds_read_b128 v[52:55], v10 offset:3072
    v_exp_f32 v85, v85
    v_cvt_pk_bf16_f32 v63, v82, v83
    v_exp_f32 v86, v86
    v_exp_f32 v87, v87
    v_cvt_pk_bf16_f32 v64, v84, v85
    v_exp_f32 v88, v88
    v_mfma_f32_32x32x16_bf16 v[124:139], v[48:51], v[72:75], v[124:139]
    ds_read_b128 v[56:59], v11 offset:3072
    s_waitcnt lgkmcnt(2)
    v_exp_f32 v89, v89
    v_cvt_pk_bf16_f32 v65, v86, v87
    v_exp_f32 v90, v90
    v_exp_f32 v91, v91
    v_cvt_pk_bf16_f32 v66, v88, v89
    v_cvt_pk_bf16_f32 v67, v90, v91
    v_mfma_f32_32x32x16_bf16 v[76:91], v[32:35], v[20:23], 0
    s_mov_b64 exec, s[28:29]
    buffer_load_dwordx4 v14, s[52:55], s18 offen offset:2048 sc1 lds
    s_mov_b64 exec, -1
    v_exp_f32 v92, v92
    v_exp_f32 v93, v93
    v_exp_f32 v94, v94
    v_exp_f32 v95, v95
    v_cvt_pk_bf16_f32 v68, v92, v93
    v_exp_f32 v96, v96
    v_mfma_f32_32x32x8_bf16 v[76:91], v[40:41], v[28:29], v[76:91]
    s_waitcnt lgkmcnt(0)
    v_exp_f32 v97, v97
    v_cvt_pk_bf16_f32 v69, v94, v95
    v_exp_f32 v98, v98
    v_exp_f32 v99, v99
    v_cvt_pk_bf16_f32 v70, v96, v97
    v_exp_f32 v100, v100
    v_mfma_f32_32x32x16_bf16 v[108:123], v[52:55], v[60:63], v[108:123]
    s_add_u32 m0, s19, 3072
    s_add_u32 s20, s18, 81920
    v_exp_f32 v101, v101
    v_cvt_pk_bf16_f32 v71, v98, v99
    v_exp_f32 v102, v102
    v_exp_f32 v103, v103
    v_cvt_pk_bf16_f32 v72, v100, v101
    v_exp_f32 v104, v104
    v_mfma_f32_32x32x16_bf16 v[108:123], v[56:59], v[64:67], v[108:123]
    buffer_load_dwordx4 v12, s[52:55], s20 offen offset:0 sc1 lds
    v_exp_f32 v105, v105
    v_cvt_pk_bf16_f32 v73, v102, v103
    v_exp_f32 v106, v106
    v_exp_f32 v107, v107
    v_cvt_pk_bf16_f32 v74, v104, v105
    v_cvt_pk_bf16_f32 v75, v106, v107
    v_mfma_f32_32x32x16_bf16 v[92:107], v[32:35], v[24:27], 0
    ds_read_b128 v[36:39], v8 offset:9216
    v_exp_f32 v76, v76
    v_exp_f32 v77, v77
    v_exp_f32 v78, v78
    v_exp_f32 v79, v79
    v_cvt_pk_bf16_f32 v60, v76, v77
    v_exp_f32 v80, v80
    v_mfma_f32_32x32x8_bf16 v[92:107], v[40:41], v[30:31], v[92:107]
    ds_read_b64 v[42:43], v9 offset:9216
    v_exp_f32 v81, v81
    v_cvt_pk_bf16_f32 v61, v78, v79
    v_exp_f32 v82, v82
    v_exp_f32 v83, v83
    v_cvt_pk_bf16_f32 v62, v80, v81
    v_exp_f32 v84, v84
    v_mfma_f32_32x32x16_bf16 v[124:139], v[52:55], v[68:71], v[124:139]
    ds_read_b128 v[44:47], v10 offset:6144
    v_exp_f32 v85, v85
    v_cvt_pk_bf16_f32 v63, v82, v83
    v_exp_f32 v86, v86
    v_exp_f32 v87, v87
    v_cvt_pk_bf16_f32 v64, v84, v85
    v_exp_f32 v88, v88
    v_mfma_f32_32x32x16_bf16 v[124:139], v[56:59], v[72:75], v[124:139]
    ds_read_b128 v[48:51], v11 offset:6144
    s_waitcnt lgkmcnt(2)
    v_exp_f32 v89, v89
    v_cvt_pk_bf16_f32 v65, v86, v87
    v_exp_f32 v90, v90
    v_exp_f32 v91, v91
    v_cvt_pk_bf16_f32 v66, v88, v89
    v_cvt_pk_bf16_f32 v67, v90, v91
    v_mfma_f32_32x32x16_bf16 v[76:91], v[36:39], v[20:23], 0
    s_mov_b64 exec, s[26:27]
    buffer_load_dwordx4 v13, s[52:55], s20 offen offset:1024 sc1 lds
    s_mov_b64 exec, -1
    v_exp_f32 v92, v92
    v_exp_f32 v93, v93
    v_exp_f32 v94, v94
    v_exp_f32 v95, v95
    v_cvt_pk_bf16_f32 v68, v92, v93
    v_exp_f32 v96, v96
    v_mfma_f32_32x32x8_bf16 v[76:91], v[42:43], v[28:29], v[76:91]
    s_waitcnt lgkmcnt(0)
    v_exp_f32 v97, v97
    v_cvt_pk_bf16_f32 v69, v94, v95
    v_exp_f32 v98, v98
    v_exp_f32 v99, v99
    v_cvt_pk_bf16_f32 v70, v96, v97
    v_exp_f32 v100, v100
    v_mfma_f32_32x32x16_bf16 v[108:123], v[44:47], v[60:63], v[108:123]
    s_mov_b64 exec, s[28:29]
    buffer_load_dwordx4 v14, s[52:55], s20 offen offset:2048 sc1 lds
    s_mov_b64 exec, -1
    v_exp_f32 v101, v101
    v_cvt_pk_bf16_f32 v71, v98, v99
    v_exp_f32 v102, v102
    v_exp_f32 v103, v103
    v_cvt_pk_bf16_f32 v72, v100, v101
    v_exp_f32 v104, v104
    v_mfma_f32_32x32x16_bf16 v[108:123], v[48:51], v[64:67], v[108:123]
    s_add_u32 s18, s18, 655360
    s_add_u32 s19, s19, 24576
    s_cmp_ge_u32 s19, 73728
    s_cselect_b32 s21, 73728, 0
    s_sub_u32 s19, s19, s21
    v_exp_f32 v105, v105
    v_cvt_pk_bf16_f32 v73, v102, v103
    v_exp_f32 v106, v106
    v_exp_f32 v107, v107
    v_cvt_pk_bf16_f32 v74, v104, v105
    v_cvt_pk_bf16_f32 v75, v106, v107
    v_mfma_f32_32x32x16_bf16 v[92:107], v[36:39], v[24:27], 0
    ds_read_b128 v[32:35], v8 offset:12288
    v_exp_f32 v76, v76
    v_exp_f32 v77, v77
    v_exp_f32 v78, v78
    v_exp_f32 v79, v79
    v_cvt_pk_bf16_f32 v60, v76, v77
    v_exp_f32 v80, v80
    v_mfma_f32_32x32x8_bf16 v[92:107], v[42:43], v[30:31], v[92:107]
    ds_read_b64 v[40:41], v9 offset:12288
    v_exp_f32 v81, v81
    v_cvt_pk_bf16_f32 v61, v78, v79
    v_exp_f32 v82, v82
    v_exp_f32 v83, v83
    v_cvt_pk_bf16_f32 v62, v80, v81
    v_exp_f32 v84, v84
    v_mfma_f32_32x32x16_bf16 v[124:139], v[44:47], v[68:71], v[124:139]
    ds_read_b128 v[52:55], v10 offset:9216
    v_exp_f32 v85, v85
    v_cvt_pk_bf16_f32 v63, v82, v83
    v_exp_f32 v86, v86
    v_exp_f32 v87, v87
    v_cvt_pk_bf16_f32 v64, v84, v85
    v_exp_f32 v88, v88
    v_mfma_f32_32x32x16_bf16 v[124:139], v[48:51], v[72:75], v[124:139]
    ds_read_b128 v[56:59], v11 offset:9216
    s_waitcnt lgkmcnt(2)
    v_exp_f32 v89, v89
    v_cvt_pk_bf16_f32 v65, v86, v87
    v_exp_f32 v90, v90
    v_exp_f32 v91, v91
    v_cvt_pk_bf16_f32 v66, v88, v89
    v_cvt_pk_bf16_f32 v67, v90, v91
    v_mfma_f32_32x32x16_bf16 v[76:91], v[32:35], v[20:23], 0
    v_exp_f32 v92, v92
    v_exp_f32 v93, v93
    v_exp_f32 v94, v94
    v_exp_f32 v95, v95
    v_cvt_pk_bf16_f32 v68, v92, v93
    v_exp_f32 v96, v96
    v_mfma_f32_32x32x8_bf16 v[76:91], v[40:41], v[28:29], v[76:91]
    s_waitcnt lgkmcnt(0)
    v_exp_f32 v97, v97
    v_cvt_pk_bf16_f32 v69, v94, v95
    v_exp_f32 v98, v98
    v_exp_f32 v99, v99
    v_cvt_pk_bf16_f32 v70, v96, v97
    v_exp_f32 v100, v100
    v_mfma_f32_32x32x16_bf16 v[108:123], v[52:55], v[60:63], v[108:123]
    v_exp_f32 v101, v101
    v_cvt_pk_bf16_f32 v71, v98, v99
    v_exp_f32 v102, v102
    v_exp_f32 v103, v103
    v_cvt_pk_bf16_f32 v72, v100, v101
    v_exp_f32 v104, v104
    v_mfma_f32_32x32x16_bf16 v[108:123], v[56:59], v[64:67], v[108:123]
    v_exp_f32 v105, v105
    v_cvt_pk_bf16_f32 v73, v102, v103
    v_exp_f32 v106, v106
    v_exp_f32 v107, v107
    v_cvt_pk_bf16_f32 v74, v104, v105
    v_cvt_pk_bf16_f32 v75, v106, v107
    v_mfma_f32_32x32x16_bf16 v[92:107], v[32:35], v[24:27], 0
    ds_read_b128 v[36:39], v8 offset:15360
    v_exp_f32 v76, v76
    v_exp_f32 v77, v77
    v_exp_f32 v78, v78
    v_exp_f32 v79, v79
    v_cvt_pk_bf16_f32 v60, v76, v77
    v_exp_f32 v80, v80
    v_mfma_f32_32x32x8_bf16 v[92:107], v[40:41], v[30:31], v[92:107]
    ds_read_b64 v[42:43], v9 offset:15360
    v_exp_f32 v81, v81
    v_cvt_pk_bf16_f32 v61, v78, v79
    v_exp_f32 v82, v82
    v_exp_f32 v83, v83
    v_cvt_pk_bf16_f32 v62, v80, v81
    v_exp_f32 v84, v84
    v_mfma_f32_32x32x16_bf16 v[124:139], v[52:55], v[68:71], v[124:139]
    ds_read_b128 v[44:47], v10 offset:12288
    v_exp_f32 v85, v85
    v_cvt_pk_bf16_f32 v63, v82, v83
    v_exp_f32 v86, v86
    v_exp_f32 v87, v87
    v_cvt_pk_bf16_f32 v64, v84, v85
    v_exp_f32 v88, v88
    v_mfma_f32_32x32x16_bf16 v[124:139], v[56:59], v[72:75], v[124:139]
    ds_read_b128 v[48:51], v11 offset:12288
    s_waitcnt lgkmcnt(2)
    v_exp_f32 v89, v89
    v_cvt_pk_bf16_f32 v65, v86, v87
    v_exp_f32 v90, v90
    v_exp_f32 v91, v91
    v_cvt_pk_bf16_f32 v66, v88, v89
    v_cvt_pk_bf16_f32 v67, v90, v91
    v_mfma_f32_32x32x16_bf16 v[76:91], v[36:39], v[20:23], 0
    v_exp_f32 v92, v92
    v_exp_f32 v93, v93
    v_exp_f32 v94, v94
    v_exp_f32 v95, v95
    v_cvt_pk_bf16_f32 v68, v92, v93
    v_exp_f32 v96, v96
    v_mfma_f32_32x32x8_bf16 v[76:91], v[42:43], v[28:29], v[76:91]
    s_waitcnt lgkmcnt(0)
    v_exp_f32 v97, v97
    v_cvt_pk_bf16_f32 v69, v94, v95
    v_exp_f32 v98, v98
    v_exp_f32 v99, v99
    v_cvt_pk_bf16_f32 v70, v96, v97
    v_exp_f32 v100, v100
    v_mfma_f32_32x32x16_bf16 v[108:123], v[44:47], v[60:63], v[108:123]
    v_exp_f32 v101, v101
    v_cvt_pk_bf16_f32 v71, v98, v99
    v_exp_f32 v102, v102
    v_exp_f32 v103, v103
    v_cvt_pk_bf16_f32 v72, v100, v101
    v_exp_f32 v104, v104
    v_mfma_f32_32x32x16_bf16 v[108:123], v[48:51], v[64:67], v[108:123]
    v_exp_f32 v105, v105
    v_cvt_pk_bf16_f32 v73, v102, v103
    v_exp_f32 v106, v106
    v_exp_f32 v107, v107
    v_cvt_pk_bf16_f32 v74, v104, v105
    v_cvt_pk_bf16_f32 v75, v106, v107
    v_mfma_f32_32x32x16_bf16 v[92:107], v[36:39], v[24:27], 0
    ds_read_b128 v[32:35], v8 offset:18432
    v_exp_f32 v76, v76
    v_exp_f32 v77, v77
    v_exp_f32 v78, v78
    v_exp_f32 v79, v79
    v_cvt_pk_bf16_f32 v60, v76, v77
    v_exp_f32 v80, v80
    v_mfma_f32_32x32x8_bf16 v[92:107], v[42:43], v[30:31], v[92:107]
    ds_read_b64 v[40:41], v9 offset:18432
    v_exp_f32 v81, v81
    v_cvt_pk_bf16_f32 v61, v78, v79
    v_exp_f32 v82, v82
    v_exp_f32 v83, v83
    v_cvt_pk_bf16_f32 v62, v80, v81
    v_exp_f32 v84, v84
    v_mfma_f32_32x32x16_bf16 v[124:139], v[44:47], v[68:71], v[124:139]
    ds_read_b128 v[52:55], v10 offset:15360
    v_exp_f32 v85, v85
    v_cvt_pk_bf16_f32 v63, v82, v83
    v_exp_f32 v86, v86
    v_exp_f32 v87, v87
    v_cvt_pk_bf16_f32 v64, v84, v85
    v_exp_f32 v88, v88
    v_mfma_f32_32x32x16_bf16 v[124:139], v[48:51], v[72:75], v[124:139]
    ds_read_b128 v[56:59], v11 offset:15360
    s_waitcnt lgkmcnt(2)
    v_exp_f32 v89, v89
    v_cvt_pk_bf16_f32 v65, v86, v87
    v_exp_f32 v90, v90
    v_exp_f32 v91, v91
    v_cvt_pk_bf16_f32 v66, v88, v89
    v_cvt_pk_bf16_f32 v67, v90, v91
    v_mfma_f32_32x32x16_bf16 v[76:91], v[32:35], v[20:23], 0
    v_exp_f32 v92, v92
    v_exp_f32 v93, v93
    v_exp_f32 v94, v94
    v_exp_f32 v95, v95
    v_cvt_pk_bf16_f32 v68, v92, v93
    v_exp_f32 v96, v96
    v_mfma_f32_32x32x8_bf16 v[76:91], v[40:41], v[28:29], v[76:91]
    s_waitcnt lgkmcnt(0)
    v_exp_f32 v97, v97
    v_cvt_pk_bf16_f32 v69, v94, v95
    v_exp_f32 v98, v98
    v_exp_f32 v99, v99
    v_cvt_pk_bf16_f32 v70, v96, v97
    v_exp_f32 v100, v100
    v_mfma_f32_32x32x16_bf16 v[108:123], v[52:55], v[60:63], v[108:123]
    v_exp_f32 v101, v101
    v_cvt_pk_bf16_f32 v71, v98, v99
    v_exp_f32 v102, v102
    v_exp_f32 v103, v103
    v_cvt_pk_bf16_f32 v72, v100, v101
    v_exp_f32 v104, v104
    v_mfma_f32_32x32x16_bf16 v[108:123], v[56:59], v[64:67], v[108:123]
    v_exp_f32 v105, v105
    v_cvt_pk_bf16_f32 v73, v102, v103
    v_exp_f32 v106, v106
    v_exp_f32 v107, v107
    v_cvt_pk_bf16_f32 v74, v104, v105
    v_cvt_pk_bf16_f32 v75, v106, v107
    v_mfma_f32_32x32x16_bf16 v[92:107], v[32:35], v[24:27], 0
    ds_read_b128 v[36:39], v8 offset:21504
    v_exp_f32 v76, v76
    v_exp_f32 v77, v77
    v_exp_f32 v78, v78
    v_exp_f32 v79, v79
    v_cvt_pk_bf16_f32 v60, v76, v77
    v_exp_f32 v80, v80
    v_mfma_f32_32x32x8_bf16 v[92:107], v[40:41], v[30:31], v[92:107]
    ds_read_b64 v[42:43], v9 offset:21504
    v_exp_f32 v81, v81
    v_cvt_pk_bf16_f32 v61, v78, v79
    v_exp_f32 v82, v82
    v_exp_f32 v83, v83
    v_cvt_pk_bf16_f32 v62, v80, v81
    v_exp_f32 v84, v84
    v_mfma_f32_32x32x16_bf16 v[124:139], v[52:55], v[68:71], v[124:139]
    ds_read_b128 v[44:47], v10 offset:18432
    v_exp_f32 v85, v85
    v_cvt_pk_bf16_f32 v63, v82, v83
    v_exp_f32 v86, v86
    v_exp_f32 v87, v87
    v_cvt_pk_bf16_f32 v64, v84, v85
    v_exp_f32 v88, v88
    v_mfma_f32_32x32x16_bf16 v[124:139], v[56:59], v[72:75], v[124:139]
    ds_read_b128 v[48:51], v11 offset:18432
    s_waitcnt lgkmcnt(2)
    v_exp_f32 v89, v89
    v_cvt_pk_bf16_f32 v65, v86, v87
    v_exp_f32 v90, v90
    v_exp_f32 v91, v91
    v_cvt_pk_bf16_f32 v66, v88, v89
    v_cvt_pk_bf16_f32 v67, v90, v91
    v_mfma_f32_32x32x16_bf16 v[76:91], v[36:39], v[20:23], 0
    v_exp_f32 v92, v92
    v_exp_f32 v93, v93
    v_exp_f32 v94, v94
    v_exp_f32 v95, v95
    v_cvt_pk_bf16_f32 v68, v92, v93
    v_exp_f32 v96, v96
    v_mfma_f32_32x32x8_bf16 v[76:91], v[42:43], v[28:29], v[76:91]
    s_waitcnt lgkmcnt(0)
    v_exp_f32 v97, v97
    v_cvt_pk_bf16_f32 v69, v94, v95
    v_exp_f32 v98, v98
    v_exp_f32 v99, v99
    v_cvt_pk_bf16_f32 v70, v96, v97
    v_exp_f32 v100, v100
    v_mfma_f32_32x32x16_bf16 v[108:123], v[44:47], v[60:63], v[108:123]
    v_exp_f32 v101, v101
    v_cvt_pk_bf16_f32 v71, v98, v99
    v_exp_f32 v102, v102
    v_exp_f32 v103, v103
    v_cvt_pk_bf16_f32 v72, v100, v101
    v_exp_f32 v104, v104
    v_mfma_f32_32x32x16_bf16 v[108:123], v[48:51], v[64:67], v[108:123]
    v_exp_f32 v105, v105
    v_cvt_pk_bf16_f32 v73, v102, v103
    v_exp_f32 v106, v106
    v_exp_f32 v107, v107
    v_cvt_pk_bf16_f32 v74, v104, v105
    v_cvt_pk_bf16_f32 v75, v106, v107
    v_mfma_f32_32x32x16_bf16 v[92:107], v[36:39], v[24:27], 0
    ds_read_b128 v[52:55], v10 offset:21504
    v_exp_f32 v76, v76
    v_exp_f32 v77, v77
    v_exp_f32 v78, v78
    v_exp_f32 v79, v79
    v_cvt_pk_bf16_f32 v60, v76, v77
    v_exp_f32 v80, v80
    v_mfma_f32_32x32x8_bf16 v[92:107], v[42:43], v[30:31], v[92:107]
    ds_read_b128 v[56:59], v11 offset:21504
    v_exp_f32 v81, v81
    v_cvt_pk_bf16_f32 v61, v78, v79
    v_exp_f32 v82, v82
    v_exp_f32 v83, v83
    v_cvt_pk_bf16_f32 v62, v80, v81
    v_exp_f32 v84, v84
    v_mfma_f32_32x32x16_bf16 v[124:139], v[44:47], v[68:71], v[124:139]
    s_waitcnt vmcnt(6) lgkmcnt(0)
    s_barrier
    v_add_u32 v8, s25, v8
    v_add_u32 v9, s25, v9
    v_add_u32 v10, s25, v10
    v_add_u32 v11, s25, v11
    v_exp_f32 v85, v85
    v_cvt_pk_bf16_f32 v63, v82, v83
    v_exp_f32 v86, v86
    v_exp_f32 v87, v87
    v_cvt_pk_bf16_f32 v64, v84, v85
    v_exp_f32 v88, v88
    v_mfma_f32_32x32x16_bf16 v[124:139], v[48:51], v[72:75], v[124:139]
    ds_read_b128 v[32:35], v8
    ds_read_b64 v[40:41], v9
    v_exp_f32 v89, v89
    v_cvt_pk_bf16_f32 v65, v86, v87
    v_exp_f32 v90, v90
    v_exp_f32 v91, v91
    v_cvt_pk_bf16_f32 v66, v88, v89
    v_cvt_pk_bf16_f32 v67, v90, v91
    s_waitcnt lgkmcnt(0)
    v_mfma_f32_32x32x16_bf16 v[76:91], v[32:35], v[20:23], 0
    s_add_u32 s17, s17, 1
    s_add_u32 s24, s24, 1
    v_exp_f32 v92, v92
    v_exp_f32 v93, v93
    v_exp_f32 v94, v94
    v_exp_f32 v95, v95
    v_cvt_pk_bf16_f32 v68, v92, v93
    v_exp_f32 v96, v96
    v_mfma_f32_32x32x8_bf16 v[76:91], v[40:41], v[28:29], v[76:91]
    v_exp_f32 v97, v97
    v_cvt_pk_bf16_f32 v69, v94, v95
    v_exp_f32 v98, v98
    v_exp_f32 v99, v99
    v_cvt_pk_bf16_f32 v70, v96, v97
    v_exp_f32 v100, v100
    v_mfma_f32_32x32x16_bf16 v[108:123], v[52:55], v[60:63], v[108:123]
    s_cmp_eq_u32 s24, 3
    s_cselect_b32 s24, 0, s24
    v_exp_f32 v101, v101
    v_cvt_pk_bf16_f32 v71, v98, v99
    v_exp_f32 v102, v102
    v_exp_f32 v103, v103
    v_cvt_pk_bf16_f32 v72, v100, v101
    v_exp_f32 v104, v104
    v_mfma_f32_32x32x16_bf16 v[108:123], v[56:59], v[64:67], v[108:123]
    s_cmp_eq_u32 s24, 2
    s_mov_b32 s25, 24576
    s_cselect_b32 s25, 0xffff4000, s25
    s_cmp_lt_u32 s17, 6
    s_cselect_b32 s54, 268435456, 0
    v_exp_f32 v105, v105
    v_cvt_pk_bf16_f32 v73, v102, v103
    v_exp_f32 v106, v106
    v_exp_f32 v107, v107
    v_cvt_pk_bf16_f32 v74, v104, v105
    v_cvt_pk_bf16_f32 v75, v106, v107
    s_cmp_lt_u32 s17, 8
    s_cbranch_scc1 L_at_loop
    v_mfma_f32_32x32x16_bf16 v[124:139], v[52:55], v[68:71], v[124:139]
    v_mfma_f32_32x32x16_bf16 v[124:139], v[56:59], v[72:75], v[124:139]
    s_mov_b32 s35, 0
    s_nop 3
L_at_fin:
    s_mov_b32 s37, 0x21800000
    s_mov_b32 s38, 0x5d800000
    s_mov_b32 s39, 0x7f61b1e6
    s_mov_b64 s[42:43], 0
    v_cmp_gt_u32 s[40:41], 32, v1
    v_mov_b32 v76, v116
    v_mov_b32 v77, v116
    v_add_f32 v82, abs(v108), abs(v109)
    v_add_f32 v83, abs(v116), abs(v117)
    v_permlane32_swap_b32 v76, v77
    v_add_f32 v83, v83, abs(v118)
    v_add_f32 v83, v83, abs(v119)
    v_rcp_f32 v76, v77
    v_cmp_nle_f32 vcc, s37, v77
    s_or_b64 s[42:43], s[42:43], vcc
    v_cmp_nge_f32 vcc, s38, v77
    s_or_b64 s[42:43], s[42:43], vcc
    v_mul_f32 v76, v76, v15
    v_cndmask_b32 v83, 0, v83, s[40:41]
    v_add_f32 v82, v82, abs(v110)
    v_add_f32 v82, v82, abs(v111)
    v_add_f32 v82, v82, abs(v112)
    v_add_f32 v82, v82, abs(v113)
    v_add_f32 v82, v82, abs(v114)
    v_add_f32 v82, v82, abs(v115)
    v_add_f32 v82, v82, v83
    v_cmp_nge_f32 vcc, s39, v82
    s_or_b64 s[42:43], s[42:43], vcc
    v_mul_f32 v108, v108, v76
    v_mul_f32 v109, v109, v76
    v_mul_f32 v110, v110, v76
    v_mul_f32 v111, v111, v76
    v_cvt_pk_bf16_f32 v60, v108, v109
    v_cvt_pk_bf16_f32 v61, v110, v111
    buffer_store_dwordx2 v[60:61], v17, s[12:15], s44 offen sc1
    v_mul_f32 v112, v112, v76
    v_mul_f32 v113, v113, v76
    v_mul_f32 v114, v114, v76
    v_mul_f32 v115, v115, v76
    v_cvt_pk_bf16_f32 v62, v112, v113
    v_cvt_pk_bf16_f32 v63, v114, v115
    buffer_store_dwordx2 v[62:63], v18, s[12:15], s44 offen sc1
    v_mul_f32 v116, v116, v76
    v_mul_f32 v117, v117, v76
    v_mul_f32 v118, v118, v76
    v_mul_f32 v119, v119, v76
    v_cvt_pk_bf16_f32 v64, v116, v117
    v_cvt_pk_bf16_f32 v65, v118, v119
    s_mov_b64 exec, s[40:41]
    buffer_store_dwordx2 v[64:65], v19, s[12:15], s44 offen sc1
    s_mov_b64 exec, -1
    s_nop 3
    v_mov_b32 v76, v132
    v_mov_b32 v77, v132
    v_add_f32 v82, abs(v124), abs(v125)
    v_add_f32 v83, abs(v132), abs(v133)
    v_permlane32_swap_b32 v76, v77
    v_add_f32 v83, v83, abs(v134)
    v_add_f32 v83, v83, abs(v135)
    v_rcp_f32 v76, v77
    v_cmp_nle_f32 vcc, s37, v77
    s_or_b64 s[42:43], s[42:43], vcc
    v_cmp_nge_f32 vcc, s38, v77
    s_or_b64 s[42:43], s[42:43], vcc
    v_mul_f32 v76, v76, v16
    v_cndmask_b32 v83, 0, v83, s[40:41]
    v_add_f32 v82, v82, abs(v126)
    v_add_f32 v82, v82, abs(v127)
    v_add_f32 v82, v82, abs(v128)
    v_add_f32 v82, v82, abs(v129)
    v_add_f32 v82, v82, abs(v130)
    v_add_f32 v82, v82, abs(v131)
    v_add_f32 v82, v82, v83
    v_cmp_nge_f32 vcc, s39, v82
    s_or_b64 s[42:43], s[42:43], vcc
    v_mul_f32 v124, v124, v76
    v_mul_f32 v125, v125, v76
    v_mul_f32 v126, v126, v76
    v_mul_f32 v127, v127, v76
    v_cvt_pk_bf16_f32 v68, v124, v125
    v_cvt_pk_bf16_f32 v69, v126, v127
    buffer_store_dwordx2 v[68:69], v17, s[12:15], s45 offen sc1
    v_mul_f32 v128, v128, v76
    v_mul_f32 v129, v129, v76
    v_mul_f32 v130, v130, v76
    v_mul_f32 v131, v131, v76
    v_cvt_pk_bf16_f32 v70, v128, v129
    v_cvt_pk_bf16_f32 v71, v130, v131
    buffer_store_dwordx2 v[70:71], v18, s[12:15], s45 offen sc1
    v_mul_f32 v132, v132, v76
    v_mul_f32 v133, v133, v76
    v_mul_f32 v134, v134, v76
    v_mul_f32 v135, v135, v76
    v_cvt_pk_bf16_f32 v72, v132, v133
    v_cvt_pk_bf16_f32 v73, v134, v135
    s_mov_b64 exec, s[40:41]
    buffer_store_dwordx2 v[72:73], v19, s[12:15], s45 offen sc1
    s_mov_b64 exec, -1
    s_cmp_lg_u64 s[42:43], 0
    s_cselect_b32 s42, 1, 0
    s_cmp_eq_u32 s35, 0
    s_cselect_b32 s42, s42, 0
    v_mov_b32 v81, s42
    s_lshl_b32 s43, s16, 2
    s_add_u32 s43, s43, 73728
    v_mov_b32 v82, s43
    ds_write_b32 v82, v81
    v_mov_b32 v82, 73728
    s_waitcnt vmcnt(0) lgkmcnt(0)
    s_barrier
    ds_read_b128 v[84:87], v82
    s_waitcnt lgkmcnt(0)
    v_or_b32 v84, v84, v85
    v_or3_b32 v84, v84, v86, v87
    s_nop 0
    v_readfirstlane_b32 s42, v84
    s_nop 0
    s_cmp_eq_u32 s42, 0
    s_cbranch_scc1 L_at_pub
    s_mov_b32 s35, 1
    s_mov_b32 s54, 268435456
    s_mul_i32 s20, s16, 163840
    s_add_u32 s18, s20, 2621440
    s_mul_i32 s19, s16, 6144
    v_lshlrev_b32 v8, 4, v1
    v_and_b32 v2, 31, v1
    v_lshlrev_b32 v3, 4, v2
    s_lshl_b32 s36, s33, 3
    s_add_u32 s36, s36, 1024
    v_add_u32 v9, s36, v3
    v_lshrrev_b32 v5, 5, v1
    v_mul_u32_u24 v6, 336, v5
    v_add3_u32 v6, v6, v3, 0
    v_add_u32 v10, 1536, v6
    v_add_u32 v11, 672, v10
    v_mov_b32 v6, 2880
    v_cmp_lt_u32 vcc, 20, v2
    s_nop 1
    v_cndmask_b32 v10, v10, v6, vcc
    v_cndmask_b32 v11, v11, v6, vcc
    v_cmp_lt_u32 vcc, 31, v1
    s_nop 1
    v_cndmask_b32 v9, v9, v6, vcc
    v_mov_b32 v108, 0
    v_mov_b32 v109, 0
    v_mov_b32 v110, 0
    v_mov_b32 v111, 0
    v_mov_b32 v112, 0
    v_mov_b32 v113, 0
    v_mov_b32 v114, 0
    v_mov_b32 v115, 0
    v_mov_b32 v116, 0
    v_mov_b32 v117, 0
    v_mov_b32 v118, 0
    v_mov_b32 v119, 0
    v_mov_b32 v120, 0
    v_mov_b32 v121, 0
    v_mov_b32 v122, 0
    v_mov_b32 v123, 0
    v_mov_b32 v124, 0
    v_mov_b32 v125, 0
    v_mov_b32 v126, 0
    v_mov_b32 v127, 0
    v_mov_b32 v128, 0
    v_mov_b32 v129, 0
    v_mov_b32 v130, 0
    v_mov_b32 v131, 0
    v_mov_b32 v132, 0
    v_mov_b32 v133, 0
    v_mov_b32 v134, 0
    v_mov_b32 v135, 0
    v_mov_b32 v136, 0
    v_mov_b32 v137, 0
    v_mov_b32 v138, 0
    v_mov_b32 v139, 0
    v_mov_b32 v140, 0xff800000
    v_mov_b32 v141, 0xff800000
    s_mov_b32 s17, 0
L_at_sloop:
    s_barrier
    s_mul_i32 s19, s16, 6144
    s_mov_b32 m0, s19
    s_nop 0
    buffer_load_dwordx4 v12, s[52:55], s18 offen offset:0 sc1 lds
    s_mov_b64 exec, s[26:27]
    buffer_load_dwordx4 v13, s[52:55], s18 offen offset:1024 sc1 lds
    s_mov_b64 exec, -1
    s_mov_b64 exec, s[28:29]
    buffer_load_dwordx4 v14, s[52:55], s18 offen offset:2048 sc1 lds
    s_mov_b64 exec, -1
    s_add_u32 m0, s19, 3072
    s_add_u32 s20, s18, 81920
    s_nop 0
    buffer_load_dwordx4 v12, s[52:55], s20 offen offset:0 sc1 lds
    s_mov_b64 exec, s[26:27]
    buffer_load_dwordx4 v13, s[52:55], s20 offen offset:1024 sc1 lds
    s_mov_b64 exec, -1
    s_mov_b64 exec, s[28:29]
    buffer_load_dwordx4 v14, s[52:55], s20 offen offset:2048 sc1 lds
    s_mov_b64 exec, -1
    s_add_u32 s18, s18, 655360
    s_add_u32 s19, s19, 24576
    s_cmp_ge_u32 s19, 73728
    s_cselect_b32 s21, 73728, 0
    s_sub_u32 s19, s19, s21
    s_waitcnt vmcnt(0)
    s_barrier
    s_mov_b32 s46, 0
L_at_stile:
    v_add_u32 v2, s46, v8
    v_add_u32 v3, s46, v9
    v_add_u32 v4, s46, v10
    v_add_u32 v5, s46, v11
    ds_read_b128 v[32:35], v2
    ds_read_b64 v[40:41], v3
    ds_read_b128 v[44:47], v4
    ds_read_b128 v[48:51], v5
    s_waitcnt lgkmcnt(0)
    v_mfma_f32_32x32x16_bf16 v[76:91], v[32:35], v[20:23], 0
    v_mfma_f32_32x32x8_bf16 v[76:91], v[40:41], v[28:29], v[76:91]
    s_nop 15
    v_max3_f32 v92, v76, v77, v78
    v_max3_f32 v92, v92, v79, v80
    v_max3_f32 v92, v92, v81, v82
    v_max3_f32 v92, v92, v83, v84
    v_max3_f32 v92, v92, v85, v86
    v_max3_f32 v92, v92, v87, v88
    v_max3_f32 v92, v92, v89, v90
    v_max_f32 v92, v92, v91
    v_mov_b32 v93, v92
    s_nop 1
    v_permlane32_swap_b32 v92, v93
    s_nop 1
    v_max3_f32 v92, v92, v93, v140
    v_sub_f32 v93, v140, v92
    v_exp_f32 v93, v93
    v_mov_b32 v140, v92
    v_sub_f32 v76, v76, v92
    v_sub_f32 v77, v77, v92
    v_sub_f32 v78, v78, v92
    v_sub_f32 v79, v79, v92
    v_sub_f32 v80, v80, v92
    v_sub_f32 v81, v81, v92
    v_sub_f32 v82, v82, v92
    v_sub_f32 v83, v83, v92
    v_sub_f32 v84, v84, v92
    v_sub_f32 v85, v85, v92
    v_sub_f32 v86, v86, v92
    v_sub_f32 v87, v87, v92
    v_sub_f32 v88, v88, v92
    v_sub_f32 v89, v89, v92
    v_sub_f32 v90, v90, v92
    v_sub_f32 v91, v91, v92
    v_exp_f32 v76, v76
    v_exp_f32 v77, v77
    v_exp_f32 v78, v78
    v_exp_f32 v79, v79
    v_exp_f32 v80, v80
    v_exp_f32 v81, v81
    v_exp_f32 v82, v82
    v_exp_f32 v83, v83
    v_exp_f32 v84, v84
    v_exp_f32 v85, v85
    v_exp_f32 v86, v86
    v_exp_f32 v87, v87
    v_exp_f32 v88, v88
    v_exp_f32 v89, v89
    v_exp_f32 v90, v90
    v_exp_f32 v91, v91
    v_mul_f32 v108, v108, v93
    v_mul_f32 v109, v109, v93
    v_mul_f32 v110, v110, v93
    v_mul_f32 v111, v111, v93
    v_mul_f32 v112, v112, v93
    v_mul_f32 v113, v113, v93
    v_mul_f32 v114, v114, v93
    v_mul_f32 v115, v115, v93
    v_mul_f32 v116, v116, v93
    v_mul_f32 v117, v117, v93
    v_mul_f32 v118, v118, v93
    v_mul_f32 v119, v119, v93
    v_mul_f32 v120, v120, v93
    v_mul_f32 v121, v121, v93
    v_mul_f32 v122, v122, v93
    v_mul_f32 v123, v123, v93
    v_cvt_pk_bf16_f32 v60, v76, v77
    v_cvt_pk_bf16_f32 v61, v78, v79
    v_cvt_pk_bf16_f32 v62, v80, v81
    v_cvt_pk_bf16_f32 v63, v82, v83
    v_cvt_pk_bf16_f32 v64, v84, v85
    v_cvt_pk_bf16_f32 v65, v86, v87
    v_cvt_pk_bf16_f32 v66, v88, v89
    v_cvt_pk_bf16_f32 v67, v90, v91
    s_nop 1
    v_mfma_f32_32x32x16_bf16 v[108:123], v[44:47], v[60:63], v[108:123]
    v_mfma_f32_32x32x16_bf16 v[108:123], v[48:51], v[64:67], v[108:123]
    s_nop 15
    v_mfma_f32_32x32x16_bf16 v[76:91], v[32:35], v[24:27], 0
    v_mfma_f32_32x32x8_bf16 v[76:91], v[40:41], v[30:31], v[76:91]
    s_nop 15
    v_max3_f32 v92, v76, v77, v78
    v_max3_f32 v92, v92, v79, v80
    v_max3_f32 v92, v92, v81, v82
    v_max3_f32 v92, v92, v83, v84
    v_max3_f32 v92, v92, v85, v86
    v_max3_f32 v92, v92, v87, v88
    v_max3_f32 v92, v92, v89, v90
    v_max_f32 v92, v92, v91
    v_mov_b32 v93, v92
    s_nop 1
    v_permlane32_swap_b32 v92, v93
    s_nop 1
    v_max3_f32 v92, v92, v93, v141
    v_sub_f32 v93, v141, v92
    v_exp_f32 v93, v93
    v_mov_b32 v141, v92
    v_sub_f32 v76, v76, v92
    v_sub_f32 v77, v77, v92
    v_sub_f32 v78, v78, v92
    v_sub_f32 v79, v79, v92
    v_sub_f32 v80, v80, v92
    v_sub_f32 v81, v81, v92
    v_sub_f32 v82, v82, v92
    v_sub_f32 v83, v83, v92
    v_sub_f32 v84, v84, v92
    v_sub_f32 v85, v85, v92
    v_sub_f32 v86, v86, v92
    v_sub_f32 v87, v87, v92
    v_sub_f32 v88, v88, v92
    v_sub_f32 v89, v89, v92
    v_sub_f32 v90, v90, v92
    v_sub_f32 v91, v91, v92
    v_exp_f32 v76, v76
    v_exp_f32 v77, v77
    v_exp_f32 v78, v78
    v_exp_f32 v79, v79
    v_exp_f32 v80, v80
    v_exp_f32 v81, v81
    v_exp_f32 v82, v82
    v_exp_f32 v83, v83
    v_exp_f32 v84, v84
    v_exp_f32 v85, v85
    v_exp_f32 v86, v86
    v_exp_f32 v87, v87
    v_exp_f32 v88, v88
    v_exp_f32 v89, v89
    v_exp_f32 v90, v90
    v_exp_f32 v91, v91
    v_mul_f32 v124, v124, v93
    v_mul_f32 v125, v125, v93
    v_mul_f32 v126, v126, v93
    v_mul_f32 v127, v127, v93
    v_mul_f32 v128, v128, v93
    v_mul_f32 v129, v129, v93
    v_mul_f32 v130, v130, v93
    v_mul_f32 v131, v131, v93
    v_mul_f32 v132, v132, v93
    v_mul_f32 v133, v133, v93
    v_mul_f32 v134, v134, v93
    v_mul_f32 v135, v135, v93
    v_mul_f32 v136, v136, v93
    v_mul_f32 v137, v137, v93
    v_mul_f32 v138, v138, v93
    v_mul_f32 v139, v139, v93
    v_cvt_pk_bf16_f32 v60, v76, v77
    v_cvt_pk_bf16_f32 v61, v78, v79
    v_cvt_pk_bf16_f32 v62, v80, v81
    v_cvt_pk_bf16_f32 v63, v82, v83
    v_cvt_pk_bf16_f32 v64, v84, v85
    v_cvt_pk_bf16_f32 v65, v86, v87
    v_cvt_pk_bf16_f32 v66, v88, v89
    v_cvt_pk_bf16_f32 v67, v90, v91
    s_nop 1
    v_mfma_f32_32x32x16_bf16 v[124:139], v[44:47], v[60:63], v[124:139]
    v_mfma_f32_32x32x16_bf16 v[124:139], v[48:51], v[64:67], v[124:139]
    s_nop 15
    s_add_u32 s46, s46, 3072
    s_cmp_lt_u32 s46, 24576
    s_cbranch_scc1 L_at_stile
    s_add_u32 s17, s17, 1
    s_cmp_lt_u32 s17, 8
    s_cbranch_scc1 L_at_sloop
    s_branch L_at_fin
L_at_pub:
    s_lshl_b32 s42, s31, 5
    s_add_u32 s42, s42, s30
    s_lshl_b32 s42, s42, 3
    s_add_u32 s42, s42, 7888896
    s_cmp_eq_u32 s16, 0
    s_cbranch_scc0 L_at_fs
    v_mov_b32 v76, s60
    v_mov_b32 v77, s61
    v_mov_b32 v78, 0
    s_mov_b64 exec, 1
    buffer_store_dwordx2 v[76:77], v78, s[12:15], s42 offen sc1
    s_mov_b64 exec, -1
L_at_fs:
    s_branch L_pend
L_role_b:
    s_load_dwordx2 s[40:41], s[0:1], 0
    s_load_dwordx2 s[42:43], s[0:1], 32
    s_load_dwordx2 s[44:45], s[0:1], 40
    s_load_dwordx2 s[46:47], s[0:1], 80
    s_load_dwordx2 s[56:57], s[0:1], 72
    s_waitcnt lgkmcnt(0)
    s_mov_b32 s4, s40
    s_and_b32 s5, s41, 0xffff
    s_mov_b32 s6, 2621440
    s_mov_b32 s7, 0x20000
    s_mov_b32 s12, s46
    s_and_b32 s13, s47, 0xffff
    s_mov_b32 s14, 268435456
    s_mov_b32 s15, 0x20000
    s_mov_b32 s48, s56
    s_and_b32 s49, s57, 0xffff
    s_mov_b32 s50, 256
    s_mov_b32 s51, 0x20000
    s_setprio 0
    s_sub_u32 s29, s2, 256
    v_and_b32 v1, 63, v0
    v_lshrrev_b32 v2, 6, v0
    s_nop 0
    v_readfirstlane_b32 s16, v2
    s_and_b32 s30, s29, 1
    s_lshl_b32 s30, s30, 3
    s_bfe_u32 s31, s29, 0x30003
    s_add_u32 s30, s30, s31
    s_bfe_u32 s32, s29, 0x20001
    s_lshl_b32 s36, s32, 2
    s_cmp_eq_u32 s32, 3
    s_cselect_b32 s36, 11, s36
    s_cmp_ge_u32 s32, 2
    s_cselect_b32 s37, 3, 4
    s_lshr_b32 s38, s29, 3
    s_lshr_b32 s31, s29, 6
    s_cmp_ge_u32 s31, s37
    s_cbranch_scc0 L_b_valid
    s_sub_u32 s33, s32, 2
    s_lshl_b32 s33, s33, 1
    s_and_b32 s34, s29, 1
    s_add_u32 s33, s33, s34
    s_lshl_b32 s33, s33, 3
    s_bfe_u32 s34, s29, 0x30003
    s_add_u32 s33, s33, s34
    s_lshl_b32 s33, s33, 2
    s_add_u32 s33, s33, s16
    v_lshlrev_b32 v210, 7, v1
    s_load_dwordx2 s[62:63], s[0:1], 32
    s_mul_i32 s69, s33, 17280
    s_waitcnt lgkmcnt(0)
    s_mov_b32 s64, s62
    s_and_b32 s65, s63, 0xffff
    s_mov_b32 s66, 2211840
    s_mov_b32 s67, 0x20000
    buffer_load_dword v211, v210, s[64:67], s69 offen
    s_add_u32 s69, s69, 8192
    buffer_load_dword v211, v210, s[64:67], s69 offen
    s_add_u32 s69, s69, 8192
    s_mov_b64 exec, 0x7f
    buffer_load_dword v211, v210, s[64:67], s69 offen
    s_mov_b64 exec, -1
    s_add_u32 s69, s69, 8192
    s_load_dwordx2 s[62:63], s[0:1], 40
    s_mul_i32 s69, s33, 17280
    s_waitcnt lgkmcnt(0)
    s_mov_b32 s64, s62
    s_and_b32 s65, s63, 0xffff
    s_mov_b32 s66, 2211840
    s_mov_b32 s67, 0x20000
    buffer_load_dword v211, v210, s[64:67], s69 offen
    s_add_u32 s69, s69, 8192
    buffer_load_dword v211, v210, s[64:67], s69 offen
    s_add_u32 s69, s69, 8192
    s_mov_b64 exec, 0x7f
    buffer_load_dword v211, v210, s[64:67], s69 offen
    s_mov_b64 exec, -1
    s_add_u32 s69, s69, 8192
    s_load_dwordx2 s[62:63], s[0:1], 48
    s_mul_i32 s69, s33, 17280
    s_waitcnt lgkmcnt(0)
    s_mov_b32 s64, s62
    s_and_b32 s65, s63, 0xffff
    s_mov_b32 s66, 2211840
    s_mov_b32 s67, 0x20000
    buffer_load_dword v211, v210, s[64:67], s69 offen
    s_add_u32 s69, s69, 8192
    buffer_load_dword v211, v210, s[64:67], s69 offen
    s_add_u32 s69, s69, 8192
    s_mov_b64 exec, 0x7f
    buffer_load_dword v211, v210, s[64:67], s69 offen
    s_mov_b64 exec, -1
    s_add_u32 s69, s69, 8192
    s_load_dwordx2 s[62:63], s[0:1], 16
    s_mul_i32 s69, s33, 6400
    s_waitcnt lgkmcnt(0)
    s_mov_b32 s64, s62
    s_and_b32 s65, s63, 0xffff
    s_mov_b32 s66, 819200
    s_mov_b32 s67, 0x20000
    s_bfm_b64 exec, 50, 0
    buffer_load_dword v211, v210, s[64:67], s69 offen
    s_mov_b64 exec, -1
    s_add_u32 s69, s69, 8192
    v_mov_b32 v6, 0
    buffer_load_dwordx2 v[4:5], v6, s[48:51], 0 offen sc1
    s_waitcnt vmcnt(0)
    s_mov_b32 s59, 0
L_b_n4_nl:
    s_memrealtime s[56:57]
    v_readfirstlane_b32 s60, v4
    v_readfirstlane_b32 s61, v5
    s_nop 1
    s_min_u32 s58, s60, s61
    s_cmp_lg_u32 s58, 0
    s_cbranch_scc0 L_b_n4_nr
    s_waitcnt lgkmcnt(0)
    s_sub_u32 s58, s56, s60
    s_add_u32 s58, s58, 500
    s_cmp_lt_u32 s58, 3000
    s_cbranch_scc1 L_b_n4_nd
    s_cmp_ge_u32 s59, 64
    s_cbranch_scc1 L_b_n4_nd
L_b_n4_nr:
    s_waitcnt lgkmcnt(0)
    s_add_u32 s59, s59, 1
    s_cmp_ge_u32 s59, 0x20000
    s_cbranch_scc1 L_b_n4_nd
    s_sleep 4
    buffer_load_dwordx2 v[4:5], v6, s[48:51], 0 offen sc1
    s_waitcnt vmcnt(0)
    s_branch L_b_n4_nl
L_b_n4_nd:
    s_waitcnt vmcnt(0)
    s_branch L_b_done
L_b_valid:
    s_add_u32 s31, s31, s36
    s_movk_i32 s24, 1280
    v_lshrrev_b32 v2, 3, v1
    v_and_b32 v3, 7, v1
    v_lshrrev_b32 v4, 1, v2
    v_mul_lo_u32 v5, v2, s24
    v_or_b32 v6, 0, v4
    v_xor_b32 v6, v6, v3
    v_lshl_add_u32 v6, v6, 4, v5
    v_add_u32 v8, 0, v6
    v_or_b32 v6, 4, v4
    v_xor_b32 v6, v6, v3
    v_lshl_add_u32 v6, v6, 4, v5
    v_add_u32 v9, 9216, v6
    v_or_b32 v6, 0, v4
    v_xor_b32 v6, v6, v3
    v_lshl_add_u32 v6, v6, 4, v5
    v_add_u32 v10, 18432, v6
    v_or_b32 v6, 4, v4
    v_xor_b32 v6, v6, v3
    v_lshl_add_u32 v6, v6, 4, v5
    v_add_u32 v11, 27648, v6
    s_movk_i32 s24, 3456
    v_lshrrev_b32 v2, 4, v1
    v_mul_lo_u32 v5, v2, s24
    v_bfe_u32 v6, v1, 2, 2
    v_xor_b32 v6, v6, v2
    v_lshl_add_u32 v5, v6, 6, v5
    v_and_b32 v7, 3, v1
    v_lshl_add_u32 v12, v7, 4, v5
    v_add_u32 v13, 12800, v12
    v_add_u32 v14, 25600, v12
    v_add_u32 v15, 38400, v12
    s_cmp_ge_u32 s16, 2
    s_cselect_b32 s42, s44, s42
    s_cselect_b32 s43, s45, s43
    s_mov_b32 s8, s42
    s_and_b32 s9, s43, 0xffff
    s_mov_b32 s10, 2211840
    s_mov_b32 s11, 0x20000
    s_lshl_b32 s34, s31, 8
    s_lshl_b32 s24, s30, 2
    s_add_u32 s24, s24, s16
    s_mul_i32 s18, s24, 40960
    s_and_b32 s24, s16, 1
    s_mul_i32 s24, s24, 55296
    s_add_u32 s19, s24, s34
    s_mov_b32 s20, 110592
    s_lshl_b32 s21, s16, 12
    s_lshl_b32 s23, s16, 12
    s_add_u32 s23, s23, 32768
    s_mov_b32 m0, s21
    s_nop 0
    buffer_load_dwordx4 v8, s[4:7], s18 offen offset:0 lds
    buffer_load_dwordx4 v9, s[4:7], s18 offen offset:1024 lds
    buffer_load_dwordx4 v10, s[4:7], s18 offen offset:2048 lds
    buffer_load_dwordx4 v11, s[4:7], s18 offen offset:3072 lds
    s_add_u32 s18, s18, 128
    s_xor_b32 s21, s21, 16384
    s_mov_b32 m0, s23
    s_nop 0
    buffer_load_dwordx4 v12, s[8:11], s19 offen offset:0 lds
    buffer_load_dwordx4 v13, s[8:11], s19 offen offset:1024 lds
    buffer_load_dwordx4 v14, s[8:11], s19 offen offset:2048 lds
    buffer_load_dwordx4 v15, s[8:11], s19 offen offset:3072 lds
    s_add_u32 s19, s19, s20
    s_add_u32 s23, s23, 16384
    s_cmp_ge_u32 s23, 81920
    s_cselect_b32 s24, 49152, 0
    s_sub_u32 s23, s23, s24
    s_mov_b32 m0, s23
    s_nop 0
    buffer_load_dwordx4 v12, s[8:11], s19 offen offset:0 lds
    buffer_load_dwordx4 v13, s[8:11], s19 offen offset:1024 lds
    buffer_load_dwordx4 v14, s[8:11], s19 offen offset:2048 lds
    buffer_load_dwordx4 v15, s[8:11], s19 offen offset:3072 lds
    s_add_u32 s19, s19, s20
    s_add_u32 s23, s23, 16384
    s_cmp_ge_u32 s23, 81920
    s_cselect_b32 s24, 49152, 0
    s_sub_u32 s23, s23, s24
    v_and_b32 v2, 31, v1
    v_lshrrev_b32 v3, 5, v1
    v_bfe_u32 v4, v1, 1, 3
    s_lshr_b32 s24, s16, 1
    s_lshl_b32 s24, s24, 13
    v_lshlrev_b32 v5, 7, v2
    v_add_u32 v5, s24, v5
    v_or_b32 v6, 0, v3
    v_xor_b32 v6, v6, v4
    v_lshl_add_u32 v16, v6, 4, v5
    v_or_b32 v6, 2, v3
    v_xor_b32 v6, v6, v4
    v_lshl_add_u32 v17, v6, 4, v5
    v_or_b32 v6, 4, v3
    v_xor_b32 v6, v6, v4
    v_lshl_add_u32 v18, v6, 4, v5
    v_or_b32 v6, 6, v3
    v_xor_b32 v6, v6, v4
    v_lshl_add_u32 v19, v6, 4, v5
    v_bfe_u32 v2, v1, 2, 2
    v_lshl_add_u32 v4, v3, 3, v2
    v_lshlrev_b32 v4, 8, v4
    v_bfe_u32 v5, v1, 4, 1
    v_lshl_add_u32 v4, v5, 5, v4
    v_and_b32 v5, 3, v1
    v_lshl_add_u32 v4, v5, 3, v4
    v_add_u32 v4, 32768, v4
    s_and_b32 s24, s16, 1
    s_lshl_b32 s24, s24, 1
    s_add_u32 s25, s24, 0
    v_xor_b32 v5, s25, v2
    v_lshl_add_u32 v20, v5, 6, v4
    s_add_u32 s25, s24, 1
    v_xor_b32 v5, s25, v2
    v_lshl_add_u32 v21, v5, 6, v4
    s_mov_b32 s17, 0
    s_mov_b32 s39, 1
    s_waitcnt vmcnt(4) lgkmcnt(0)
    s_barrier
    ds_read_b128 v[24:27], v16 offset:0
    ds_read_b128 v[28:31], v16 offset:4096
    ds_read_b64_tr_b16 v[32:33], v20 offset:0
    ds_read_b64_tr_b16 v[34:35], v20 offset:1024
    ds_read_b64_tr_b16 v[36:37], v21 offset:0
    ds_read_b64_tr_b16 v[38:39], v21 offset:1024
    ds_read_b64_tr_b16 v[40:41], v20 offset:8192
    ds_read_b64_tr_b16 v[42:43], v20 offset:9216
    ds_read_b64_tr_b16 v[44:45], v21 offset:8192
    ds_read_b64_tr_b16 v[46:47], v21 offset:9216
    s_mov_b32 m0, s21
    s_nop 0
    buffer_load_dwordx4 v8, s[4:7], s18 offen offset:0 lds
    buffer_load_dwordx4 v9, s[4:7], s18 offen offset:1024 lds
    buffer_load_dwordx4 v10, s[4:7], s18 offen offset:2048 lds
    buffer_load_dwordx4 v11, s[4:7], s18 offen offset:3072 lds
    s_add_u32 s18, s18, 128
    s_xor_b32 s21, s21, 16384
    s_waitcnt lgkmcnt(0)
    v_mfma_f32_32x32x16_bf16 v[72:87], v[32:35], v[24:27], 0
    ds_read_b128 v[48:51], v17 offset:0
    ds_read_b128 v[52:55], v17 offset:4096
    ds_read_b64_tr_b16 v[56:57], v20 offset:4096
    v_mfma_f32_32x32x16_bf16 v[136:151], v[32:35], v[28:31], 0
    ds_read_b64_tr_b16 v[58:59], v20 offset:5120
    ds_read_b64_tr_b16 v[60:61], v21 offset:4096
    ds_read_b64_tr_b16 v[62:63], v21 offset:5120
    v_mfma_f32_32x32x16_bf16 v[88:103], v[36:39], v[24:27], 0
    ds_read_b64_tr_b16 v[64:65], v20 offset:12288
    ds_read_b64_tr_b16 v[66:67], v20 offset:13312
    ds_read_b64_tr_b16 v[68:69], v21 offset:12288
    ds_read_b64_tr_b16 v[70:71], v21 offset:13312
    s_mov_b32 m0, s23
    v_mfma_f32_32x32x16_bf16 v[152:167], v[36:39], v[28:31], 0
    buffer_load_dwordx4 v12, s[8:11], s19 offen offset:0 lds
    v_mfma_f32_32x32x16_bf16 v[104:119], v[40:43], v[24:27], 0
    buffer_load_dwordx4 v13, s[8:11], s19 offen offset:1024 lds
    v_mfma_f32_32x32x16_bf16 v[168:183], v[40:43], v[28:31], 0
    buffer_load_dwordx4 v14, s[8:11], s19 offen offset:2048 lds
    v_mfma_f32_32x32x16_bf16 v[120:135], v[44:47], v[24:27], 0
    buffer_load_dwordx4 v15, s[8:11], s19 offen offset:3072 lds
    s_add_u32 s19, s19, s20
    s_add_u32 s23, s23, 16384
    s_cmp_ge_u32 s23, 81920
    s_cselect_b32 s24, 49152, 0
    s_sub_u32 s23, s23, s24
    s_add_u32 s17, s17, 1
    s_cmp_eq_u32 s17, 3
    s_mov_b32 s26, 16384
    s_cselect_b32 s26, 0xffff8000, s26
    s_cselect_b32 s17, 0, s17
    v_mfma_f32_32x32x16_bf16 v[184:199], v[44:47], v[28:31], 0
    v_add_u32 v20, s26, v20
    v_add_u32 v21, s26, v21
    s_waitcnt vmcnt(8) lgkmcnt(0)
    s_barrier
    v_mfma_f32_32x32x16_bf16 v[72:87], v[56:59], v[48:51], v[72:87]
    ds_read_b128 v[24:27], v18 offset:0
    ds_read_b128 v[28:31], v18 offset:4096
    ds_read_b64_tr_b16 v[32:33], v20 offset:0
    v_mfma_f32_32x32x16_bf16 v[136:151], v[56:59], v[52:55], v[136:151]
    ds_read_b64_tr_b16 v[34:35], v20 offset:1024
    ds_read_b64_tr_b16 v[36:37], v21 offset:0
    ds_read_b64_tr_b16 v[38:39], v21 offset:1024
    v_mfma_f32_32x32x16_bf16 v[88:103], v[60:63], v[48:51], v[88:103]
    ds_read_b64_tr_b16 v[40:41], v20 offset:8192
    ds_read_b64_tr_b16 v[42:43], v20 offset:9216
    ds_read_b64_tr_b16 v[44:45], v21 offset:8192
    ds_read_b64_tr_b16 v[46:47], v21 offset:9216
    v_mfma_f32_32x32x16_bf16 v[152:167], v[60:63], v[52:55], v[152:167]
    v_mfma_f32_32x32x16_bf16 v[104:119], v[64:67], v[48:51], v[104:119]
    v_mfma_f32_32x32x16_bf16 v[168:183], v[64:67], v[52:55], v[168:183]
    v_mfma_f32_32x32x16_bf16 v[120:135], v[68:71], v[48:51], v[120:135]
    v_mfma_f32_32x32x16_bf16 v[184:199], v[68:71], v[52:55], v[184:199]
    s_waitcnt lgkmcnt(0)
    v_mfma_f32_32x32x16_bf16 v[72:87], v[32:35], v[24:27], v[72:87]
    ds_read_b128 v[48:51], v19 offset:0
    ds_read_b128 v[52:55], v19 offset:4096
    ds_read_b64_tr_b16 v[56:57], v20 offset:4096
    v_mfma_f32_32x32x16_bf16 v[136:151], v[32:35], v[28:31], v[136:151]
    ds_read_b64_tr_b16 v[58:59], v20 offset:5120
    ds_read_b64_tr_b16 v[60:61], v21 offset:4096
    ds_read_b64_tr_b16 v[62:63], v21 offset:5120
    v_mfma_f32_32x32x16_bf16 v[88:103], v[36:39], v[24:27], v[88:103]
    ds_read_b64_tr_b16 v[64:65], v20 offset:12288
    ds_read_b64_tr_b16 v[66:67], v20 offset:13312
    ds_read_b64_tr_b16 v[68:69], v21 offset:12288
    ds_read_b64_tr_b16 v[70:71], v21 offset:13312
    s_mov_b32 m0, s23
    v_mfma_f32_32x32x16_bf16 v[152:167], v[36:39], v[28:31], v[152:167]
    buffer_load_dwordx4 v12, s[8:11], s19 offen offset:0 lds
    v_mfma_f32_32x32x16_bf16 v[104:119], v[40:43], v[24:27], v[104:119]
    buffer_load_dwordx4 v13, s[8:11], s19 offen offset:1024 lds
    v_mfma_f32_32x32x16_bf16 v[168:183], v[40:43], v[28:31], v[168:183]
    buffer_load_dwordx4 v14, s[8:11], s19 offen offset:2048 lds
    v_mfma_f32_32x32x16_bf16 v[120:135], v[44:47], v[24:27], v[120:135]
    buffer_load_dwordx4 v15, s[8:11], s19 offen offset:3072 lds
    s_add_u32 s19, s19, s20
    s_add_u32 s23, s23, 16384
    s_cmp_ge_u32 s23, 81920
    s_cselect_b32 s24, 49152, 0
    s_sub_u32 s23, s23, s24
    s_add_u32 s17, s17, 1
    s_cmp_eq_u32 s17, 3
    s_mov_b32 s26, 16384
    s_cselect_b32 s26, 0xffff8000, s26
    s_cselect_b32 s17, 0, s17
    v_mfma_f32_32x32x16_bf16 v[184:199], v[44:47], v[28:31], v[184:199]
    v_add_u32 v20, s26, v20
    v_add_u32 v21, s26, v21
    v_xor_b32 v16, 16384, v16
    v_xor_b32 v17, 16384, v17
    v_xor_b32 v18, 16384, v18
    v_xor_b32 v19, 16384, v19
.p2align 4
L_b_loop:
    s_waitcnt vmcnt(4) lgkmcnt(0)
    s_barrier
    v_mfma_f32_32x32x16_bf16 v[72:87], v[56:59], v[48:51], v[72:87]
    ds_read_b128 v[24:27], v16 offset:0
    ds_read_b128 v[28:31], v16 offset:4096
    ds_read_b64_tr_b16 v[32:33], v20 offset:0
    v_mfma_f32_32x32x16_bf16 v[136:151], v[56:59], v[52:55], v[136:151]
    ds_read_b64_tr_b16 v[34:35], v20 offset:1024
    ds_read_b64_tr_b16 v[36:37], v21 offset:0
    ds_read_b64_tr_b16 v[38:39], v21 offset:1024
    v_mfma_f32_32x32x16_bf16 v[88:103], v[60:63], v[48:51], v[88:103]
    ds_read_b64_tr_b16 v[40:41], v20 offset:8192
    ds_read_b64_tr_b16 v[42:43], v20 offset:9216
    ds_read_b64_tr_b16 v[44:45], v21 offset:8192
    ds_read_b64_tr_b16 v[46:47], v21 offset:9216
    s_mov_b32 m0, s21
    v_mfma_f32_32x32x16_bf16 v[152:167], v[60:63], v[52:55], v[152:167]
    buffer_load_dwordx4 v8, s[4:7], s18 offen offset:0 lds
    v_mfma_f32_32x32x16_bf16 v[104:119], v[64:67], v[48:51], v[104:119]
    buffer_load_dwordx4 v9, s[4:7], s18 offen offset:1024 lds
    v_mfma_f32_32x32x16_bf16 v[168:183], v[64:67], v[52:55], v[168:183]
    buffer_load_dwordx4 v10, s[4:7], s18 offen offset:2048 lds
    v_mfma_f32_32x32x16_bf16 v[120:135], v[68:71], v[48:51], v[120:135]
    buffer_load_dwordx4 v11, s[4:7], s18 offen offset:3072 lds
    s_add_u32 s18, s18, 128
    s_xor_b32 s21, s21, 16384
    v_mfma_f32_32x32x16_bf16 v[184:199], v[68:71], v[52:55], v[184:199]
    s_waitcnt lgkmcnt(0)
    v_mfma_f32_32x32x16_bf16 v[72:87], v[32:35], v[24:27], v[72:87]
    ds_read_b128 v[48:51], v17 offset:0
    ds_read_b128 v[52:55], v17 offset:4096
    ds_read_b64_tr_b16 v[56:57], v20 offset:4096
    v_mfma_f32_32x32x16_bf16 v[136:151], v[32:35], v[28:31], v[136:151]
    ds_read_b64_tr_b16 v[58:59], v20 offset:5120
    ds_read_b64_tr_b16 v[60:61], v21 offset:4096
    ds_read_b64_tr_b16 v[62:63], v21 offset:5120
    v_mfma_f32_32x32x16_bf16 v[88:103], v[36:39], v[24:27], v[88:103]
    ds_read_b64_tr_b16 v[64:65], v20 offset:12288
    ds_read_b64_tr_b16 v[66:67], v20 offset:13312
    ds_read_b64_tr_b16 v[68:69], v21 offset:12288
    ds_read_b64_tr_b16 v[70:71], v21 offset:13312
    s_mov_b32 m0, s23
    v_mfma_f32_32x32x16_bf16 v[152:167], v[36:39], v[28:31], v[152:167]
    buffer_load_dwordx4 v12, s[8:11], s19 offen offset:0 lds
    v_mfma_f32_32x32x16_bf16 v[104:119], v[40:43], v[24:27], v[104:119]
    buffer_load_dwordx4 v13, s[8:11], s19 offen offset:1024 lds
    v_mfma_f32_32x32x16_bf16 v[168:183], v[40:43], v[28:31], v[168:183]
    buffer_load_dwordx4 v14, s[8:11], s19 offen offset:2048 lds
    v_mfma_f32_32x32x16_bf16 v[120:135], v[44:47], v[24:27], v[120:135]
    buffer_load_dwordx4 v15, s[8:11], s19 offen offset:3072 lds
    s_add_u32 s19, s19, s20
    s_add_u32 s23, s23, 16384
    s_cmp_ge_u32 s23, 81920
    s_cselect_b32 s24, 49152, 0
    s_sub_u32 s23, s23, s24
    s_add_u32 s17, s17, 1
    s_cmp_eq_u32 s17, 3
    s_mov_b32 s26, 16384
    s_cselect_b32 s26, 0xffff8000, s26
    s_cselect_b32 s17, 0, s17
    v_mfma_f32_32x32x16_bf16 v[184:199], v[44:47], v[28:31], v[184:199]
    v_add_u32 v20, s26, v20
    v_add_u32 v21, s26, v21
    s_waitcnt vmcnt(8) lgkmcnt(0)
    s_barrier
    v_mfma_f32_32x32x16_bf16 v[72:87], v[56:59], v[48:51], v[72:87]
    ds_read_b128 v[24:27], v18 offset:0
    ds_read_b128 v[28:31], v18 offset:4096
    ds_read_b64_tr_b16 v[32:33], v20 offset:0
    v_mfma_f32_32x32x16_bf16 v[136:151], v[56:59], v[52:55], v[136:151]
    ds_read_b64_tr_b16 v[34:35], v20 offset:1024
    ds_read_b64_tr_b16 v[36:37], v21 offset:0
    ds_read_b64_tr_b16 v[38:39], v21 offset:1024
    v_mfma_f32_32x32x16_bf16 v[88:103], v[60:63], v[48:51], v[88:103]
    ds_read_b64_tr_b16 v[40:41], v20 offset:8192
    ds_read_b64_tr_b16 v[42:43], v20 offset:9216
    ds_read_b64_tr_b16 v[44:45], v21 offset:8192
    ds_read_b64_tr_b16 v[46:47], v21 offset:9216
    v_mfma_f32_32x32x16_bf16 v[152:167], v[60:63], v[52:55], v[152:167]
    v_mfma_f32_32x32x16_bf16 v[104:119], v[64:67], v[48:51], v[104:119]
    v_mfma_f32_32x32x16_bf16 v[168:183], v[64:67], v[52:55], v[168:183]
    v_mfma_f32_32x32x16_bf16 v[120:135], v[68:71], v[48:51], v[120:135]
    v_mfma_f32_32x32x16_bf16 v[184:199], v[68:71], v[52:55], v[184:199]
    s_waitcnt lgkmcnt(0)
    v_mfma_f32_32x32x16_bf16 v[72:87], v[32:35], v[24:27], v[72:87]
    ds_read_b128 v[48:51], v19 offset:0
    ds_read_b128 v[52:55], v19 offset:4096
    ds_read_b64_tr_b16 v[56:57], v20 offset:4096
    v_mfma_f32_32x32x16_bf16 v[136:151], v[32:35], v[28:31], v[136:151]
    ds_read_b64_tr_b16 v[58:59], v20 offset:5120
    ds_read_b64_tr_b16 v[60:61], v21 offset:4096
    ds_read_b64_tr_b16 v[62:63], v21 offset:5120
    v_mfma_f32_32x32x16_bf16 v[88:103], v[36:39], v[24:27], v[88:103]
    ds_read_b64_tr_b16 v[64:65], v20 offset:12288
    ds_read_b64_tr_b16 v[66:67], v20 offset:13312
    ds_read_b64_tr_b16 v[68:69], v21 offset:12288
    ds_read_b64_tr_b16 v[70:71], v21 offset:13312
    s_mov_b32 m0, s23
    v_mfma_f32_32x32x16_bf16 v[152:167], v[36:39], v[28:31], v[152:167]
    buffer_load_dwordx4 v12, s[8:11], s19 offen offset:0 lds
    v_mfma_f32_32x32x16_bf16 v[104:119], v[40:43], v[24:27], v[104:119]
    buffer_load_dwordx4 v13, s[8:11], s19 offen offset:1024 lds
    v_mfma_f32_32x32x16_bf16 v[168:183], v[40:43], v[28:31], v[168:183]
    buffer_load_dwordx4 v14, s[8:11], s19 offen offset:2048 lds
    v_mfma_f32_32x32x16_bf16 v[120:135], v[44:47], v[24:27], v[120:135]
    buffer_load_dwordx4 v15, s[8:11], s19 offen offset:3072 lds
    s_add_u32 s19, s19, s20
    s_add_u32 s23, s23, 16384
    s_cmp_ge_u32 s23, 81920
    s_cselect_b32 s24, 49152, 0
    s_sub_u32 s23, s23, s24
    s_add_u32 s17, s17, 1
    s_cmp_eq_u32 s17, 3
    s_mov_b32 s26, 16384
    s_cselect_b32 s26, 0xffff8000, s26
    s_cselect_b32 s17, 0, s17
    v_mfma_f32_32x32x16_bf16 v[184:199], v[44:47], v[28:31], v[184:199]
    v_add_u32 v20, s26, v20
    v_add_u32 v21, s26, v21
    v_xor_b32 v16, 16384, v16
    v_xor_b32 v17, 16384, v17
    v_xor_b32 v18, 16384, v18
    v_xor_b32 v19, 16384, v19
    s_add_u32 s39, s39, 1
    s_cmp_lt_u32 s39, 9
    s_cbranch_scc1 L_b_loop
    s_waitcnt vmcnt(4) lgkmcnt(0)
    s_barrier
    v_mfma_f32_32x32x16_bf16 v[72:87], v[56:59], v[48:51], v[72:87]
    ds_read_b128 v[24:27], v16 offset:0
    ds_read_b128 v[28:31], v16 offset:4096
    ds_read_b64_tr_b16 v[32:33], v20 offset:0
    v_mfma_f32_32x32x16_bf16 v[136:151], v[56:59], v[52:55], v[136:151]
    ds_read_b64_tr_b16 v[34:35], v20 offset:1024
    ds_read_b64_tr_b16 v[36:37], v21 offset:0
    ds_read_b64_tr_b16 v[38:39], v21 offset:1024
    v_mfma_f32_32x32x16_bf16 v[88:103], v[60:63], v[48:51], v[88:103]
    ds_read_b64_tr_b16 v[40:41], v20 offset:8192
    ds_read_b64_tr_b16 v[42:43], v20 offset:9216
    ds_read_b64_tr_b16 v[44:45], v21 offset:8192
    ds_read_b64_tr_b16 v[46:47], v21 offset:9216
    v_mfma_f32_32x32x16_bf16 v[152:167], v[60:63], v[52:55], v[152:167]
    v_mfma_f32_32x32x16_bf16 v[104:119], v[64:67], v[48:51], v[104:119]
    v_mfma_f32_32x32x16_bf16 v[168:183], v[64:67], v[52:55], v[168:183]
    v_mfma_f32_32x32x16_bf16 v[120:135], v[68:71], v[48:51], v[120:135]
    v_mfma_f32_32x32x16_bf16 v[184:199], v[68:71], v[52:55], v[184:199]
    s_waitcnt lgkmcnt(0)
    v_mfma_f32_32x32x16_bf16 v[72:87], v[32:35], v[24:27], v[72:87]
    ds_read_b128 v[48:51], v17 offset:0
    ds_read_b128 v[52:55], v17 offset:4096
    ds_read_b64_tr_b16 v[56:57], v20 offset:4096
    v_mfma_f32_32x32x16_bf16 v[136:151], v[32:35], v[28:31], v[136:151]
    ds_read_b64_tr_b16 v[58:59], v20 offset:5120
    ds_read_b64_tr_b16 v[60:61], v21 offset:4096
    ds_read_b64_tr_b16 v[62:63], v21 offset:5120
    v_mfma_f32_32x32x16_bf16 v[88:103], v[36:39], v[24:27], v[88:103]
    ds_read_b64_tr_b16 v[64:65], v20 offset:12288
    ds_read_b64_tr_b16 v[66:67], v20 offset:13312
    ds_read_b64_tr_b16 v[68:69], v21 offset:12288
    ds_read_b64_tr_b16 v[70:71], v21 offset:13312
    v_mfma_f32_32x32x16_bf16 v[152:167], v[36:39], v[28:31], v[152:167]
    v_mfma_f32_32x32x16_bf16 v[104:119], v[40:43], v[24:27], v[104:119]
    v_mfma_f32_32x32x16_bf16 v[168:183], v[40:43], v[28:31], v[168:183]
    v_mfma_f32_32x32x16_bf16 v[120:135], v[44:47], v[24:27], v[120:135]
    s_add_u32 s17, s17, 1
    s_cmp_eq_u32 s17, 3
    s_mov_b32 s26, 16384
    s_cselect_b32 s26, 0xffff8000, s26
    s_cselect_b32 s17, 0, s17
    v_mfma_f32_32x32x16_bf16 v[184:199], v[44:47], v[28:31], v[184:199]
    v_add_u32 v20, s26, v20
    v_add_u32 v21, s26, v21
    s_waitcnt vmcnt(0) lgkmcnt(0)
    s_barrier
    v_mfma_f32_32x32x16_bf16 v[72:87], v[56:59], v[48:51], v[72:87]
    ds_read_b128 v[24:27], v18 offset:0
    ds_read_b128 v[28:31], v18 offset:4096
    ds_read_b64_tr_b16 v[32:33], v20 offset:0
    v_mfma_f32_32x32x16_bf16 v[136:151], v[56:59], v[52:55], v[136:151]
    ds_read_b64_tr_b16 v[34:35], v20 offset:1024
    ds_read_b64_tr_b16 v[36:37], v21 offset:0
    ds_read_b64_tr_b16 v[38:39], v21 offset:1024
    v_mfma_f32_32x32x16_bf16 v[88:103], v[60:63], v[48:51], v[88:103]
    ds_read_b64_tr_b16 v[40:41], v20 offset:8192
    ds_read_b64_tr_b16 v[42:43], v20 offset:9216
    ds_read_b64_tr_b16 v[44:45], v21 offset:8192
    ds_read_b64_tr_b16 v[46:47], v21 offset:9216
    v_mfma_f32_32x32x16_bf16 v[152:167], v[60:63], v[52:55], v[152:167]
    v_mfma_f32_32x32x16_bf16 v[104:119], v[64:67], v[48:51], v[104:119]
    v_mfma_f32_32x32x16_bf16 v[168:183], v[64:67], v[52:55], v[168:183]
    v_mfma_f32_32x32x16_bf16 v[120:135], v[68:71], v[48:51], v[120:135]
    v_mfma_f32_32x32x16_bf16 v[184:199], v[68:71], v[52:55], v[184:199]
    s_waitcnt lgkmcnt(0)
    v_mfma_f32_32x32x16_bf16 v[72:87], v[32:35], v[24:27], v[72:87]
    ds_read_b128 v[48:51], v19 offset:0
    ds_read_b128 v[52:55], v19 offset:4096
    ds_read_b64_tr_b16 v[56:57], v20 offset:4096
    v_mfma_f32_32x32x16_bf16 v[136:151], v[32:35], v[28:31], v[136:151]
    ds_read_b64_tr_b16 v[58:59], v20 offset:5120
    ds_read_b64_tr_b16 v[60:61], v21 offset:4096
    ds_read_b64_tr_b16 v[62:63], v21 offset:5120
    v_mfma_f32_32x32x16_bf16 v[88:103], v[36:39], v[24:27], v[88:103]
    ds_read_b64_tr_b16 v[64:65], v20 offset:12288
    ds_read_b64_tr_b16 v[66:67], v20 offset:13312
    ds_read_b64_tr_b16 v[68:69], v21 offset:12288
    ds_read_b64_tr_b16 v[70:71], v21 offset:13312
    v_mfma_f32_32x32x16_bf16 v[152:167], v[36:39], v[28:31], v[152:167]
    v_mfma_f32_32x32x16_bf16 v[104:119], v[40:43], v[24:27], v[104:119]
    v_mfma_f32_32x32x16_bf16 v[168:183], v[40:43], v[28:31], v[168:183]
    v_mfma_f32_32x32x16_bf16 v[120:135], v[44:47], v[24:27], v[120:135]
    s_add_u32 s17, s17, 1
    s_cmp_eq_u32 s17, 3
    s_mov_b32 s26, 16384
    s_cselect_b32 s26, 0xffff8000, s26
    s_cselect_b32 s17, 0, s17
    v_mfma_f32_32x32x16_bf16 v[184:199], v[44:47], v[28:31], v[184:199]
    v_add_u32 v20, s26, v20
    v_add_u32 v21, s26, v21
    v_xor_b32 v16, 16384, v16
    v_xor_b32 v17, 16384, v17
    v_xor_b32 v18, 16384, v18
    v_xor_b32 v19, 16384, v19
    s_waitcnt lgkmcnt(0)
    v_mfma_f32_32x32x16_bf16 v[72:87], v[56:59], v[48:51], v[72:87]
    v_mfma_f32_32x32x16_bf16 v[136:151], v[56:59], v[52:55], v[136:151]
    v_mfma_f32_32x32x16_bf16 v[88:103], v[60:63], v[48:51], v[88:103]
    v_mfma_f32_32x32x16_bf16 v[152:167], v[60:63], v[52:55], v[152:167]
    v_mfma_f32_32x32x16_bf16 v[104:119], v[64:67], v[48:51], v[104:119]
    v_mfma_f32_32x32x16_bf16 v[168:183], v[64:67], v[52:55], v[168:183]
    v_mfma_f32_32x32x16_bf16 v[120:135], v[68:71], v[48:51], v[120:135]
    v_mfma_f32_32x32x16_bf16 v[184:199], v[68:71], v[52:55], v[184:199]
    s_nop 15
    v_mov_b32 v4, 0
    buffer_load_dwordx2 v[2:3], v4, s[48:51], 0 offen sc1
    s_and_b32 s33, s16, 1
    s_lshl_b32 s33, s33, 1
    s_lshl_b32 s34, s31, 2
    s_add_u32 s33, s33, s34
    s_cmp_ge_u32 s33, 54
    s_cbranch_scc1 L_b_noepi
    s_lshr_b32 s34, s16, 1
    s_lshl_b32 s34, s34, 2
    s_lshl_b32 s35, s30, 3
    s_add_u32 s34, s34, s35
    s_mul_i32 s34, s34, 75776
    s_lshl_b32 s35, s33, 10
    s_add_u32 s34, s34, s35
    s_add_u32 s36, s34, 7929856
    s_setprio 3
    v_and_b32 v24, 15, v1
    v_lshlrev_b32 v24, 4, v24
    v_bfe_u32 v25, v1, 4, 1
    s_mov_b32 s24, 75776
    v_mad_u32_u24 v24, v25, s24, v24
    v_lshrrev_b32 v25, 5, v1
    v_lshl_add_u32 v24, v25, 8, v24
    s_mov_b32 s24, 0xbfb8aa3b
    s_add_u32 s37, s36, 151552
    v_mul_f32 v72, s24, v72
    v_mul_f32 v73, s24, v73
    v_mul_f32 v74, s24, v74
    v_mul_f32 v75, s24, v75
    v_mul_f32 v76, s24, v76
    v_mul_f32 v77, s24, v77
    v_mul_f32 v78, s24, v78
    v_mul_f32 v79, s24, v79
    v_mul_f32 v80, s24, v80
    v_mul_f32 v81, s24, v81
    v_mul_f32 v82, s24, v82
    v_mul_f32 v83, s24, v83
    v_mul_f32 v84, s24, v84
    v_mul_f32 v85, s24, v85
    v_mul_f32 v86, s24, v86
    v_mul_f32 v87, s24, v87
    v_exp_f32 v72, v72
    v_exp_f32 v73, v73
    v_exp_f32 v74, v74
    v_exp_f32 v75, v75
    v_exp_f32 v76, v76
    v_exp_f32 v77, v77
    v_exp_f32 v78, v78
    v_exp_f32 v79, v79
    v_exp_f32 v80, v80
    v_exp_f32 v81, v81
    v_exp_f32 v82, v82
    v_exp_f32 v83, v83
    v_exp_f32 v84, v84
    v_exp_f32 v85, v85
    v_exp_f32 v86, v86
    v_exp_f32 v87, v87
    v_add_f32 v72, 1.0, v72
    v_add_f32 v73, 1.0, v73
    v_add_f32 v74, 1.0, v74
    v_add_f32 v75, 1.0, v75
    v_add_f32 v76, 1.0, v76
    v_add_f32 v77, 1.0, v77
    v_add_f32 v78, 1.0, v78
    v_add_f32 v79, 1.0, v79
    v_add_f32 v80, 1.0, v80
    v_add_f32 v81, 1.0, v81
    v_add_f32 v82, 1.0, v82
    v_add_f32 v83, 1.0, v83
    v_add_f32 v84, 1.0, v84
    v_add_f32 v85, 1.0, v85
    v_add_f32 v86, 1.0, v86
    v_add_f32 v87, 1.0, v87
    v_rcp_f32 v72, v72
    v_rcp_f32 v73, v73
    v_rcp_f32 v74, v74
    v_rcp_f32 v75, v75
    v_rcp_f32 v76, v76
    v_rcp_f32 v77, v77
    v_rcp_f32 v78, v78
    v_rcp_f32 v79, v79
    v_rcp_f32 v80, v80
    v_rcp_f32 v81, v81
    v_rcp_f32 v82, v82
    v_rcp_f32 v83, v83
    v_rcp_f32 v84, v84
    v_rcp_f32 v85, v85
    v_rcp_f32 v86, v86
    v_rcp_f32 v87, v87
    v_mul_f32 v104, v104, v72
    v_mul_f32 v105, v105, v73
    v_mul_f32 v106, v106, v74
    v_mul_f32 v107, v107, v75
    v_mul_f32 v108, v108, v76
    v_mul_f32 v109, v109, v77
    v_mul_f32 v110, v110, v78
    v_mul_f32 v111, v111, v79
    v_mul_f32 v112, v112, v80
    v_mul_f32 v113, v113, v81
    v_mul_f32 v114, v114, v82
    v_mul_f32 v115, v115, v83
    v_mul_f32 v116, v116, v84
    v_mul_f32 v117, v117, v85
    v_mul_f32 v118, v118, v86
    v_mul_f32 v119, v119, v87
    v_cvt_pk_bf16_f32 v28, v104, v105
    v_cvt_pk_bf16_f32 v29, v106, v107
    v_cvt_pk_bf16_f32 v30, v112, v113
    v_cvt_pk_bf16_f32 v31, v114, v115
    buffer_store_dwordx4 v[28:31], v24, s[12:15], s36 offen offset:0 sc1
    v_cvt_pk_bf16_f32 v32, v108, v109
    v_cvt_pk_bf16_f32 v33, v110, v111
    v_cvt_pk_bf16_f32 v34, v116, v117
    v_cvt_pk_bf16_f32 v35, v118, v119
    buffer_store_dwordx4 v[32:35], v24, s[12:15], s36 offen offset:512 sc1
    v_mul_f32 v136, s24, v136
    v_mul_f32 v137, s24, v137
    v_mul_f32 v138, s24, v138
    v_mul_f32 v139, s24, v139
    v_mul_f32 v140, s24, v140
    v_mul_f32 v141, s24, v141
    v_mul_f32 v142, s24, v142
    v_mul_f32 v143, s24, v143
    v_mul_f32 v144, s24, v144
    v_mul_f32 v145, s24, v145
    v_mul_f32 v146, s24, v146
    v_mul_f32 v147, s24, v147
    v_mul_f32 v148, s24, v148
    v_mul_f32 v149, s24, v149
    v_mul_f32 v150, s24, v150
    v_mul_f32 v151, s24, v151
    v_exp_f32 v136, v136
    v_exp_f32 v137, v137
    v_exp_f32 v138, v138
    v_exp_f32 v139, v139
    v_exp_f32 v140, v140
    v_exp_f32 v141, v141
    v_exp_f32 v142, v142
    v_exp_f32 v143, v143
    v_exp_f32 v144, v144
    v_exp_f32 v145, v145
    v_exp_f32 v146, v146
    v_exp_f32 v147, v147
    v_exp_f32 v148, v148
    v_exp_f32 v149, v149
    v_exp_f32 v150, v150
    v_exp_f32 v151, v151
    v_add_f32 v136, 1.0, v136
    v_add_f32 v137, 1.0, v137
    v_add_f32 v138, 1.0, v138
    v_add_f32 v139, 1.0, v139
    v_add_f32 v140, 1.0, v140
    v_add_f32 v141, 1.0, v141
    v_add_f32 v142, 1.0, v142
    v_add_f32 v143, 1.0, v143
    v_add_f32 v144, 1.0, v144
    v_add_f32 v145, 1.0, v145
    v_add_f32 v146, 1.0, v146
    v_add_f32 v147, 1.0, v147
    v_add_f32 v148, 1.0, v148
    v_add_f32 v149, 1.0, v149
    v_add_f32 v150, 1.0, v150
    v_add_f32 v151, 1.0, v151
    v_rcp_f32 v136, v136
    v_rcp_f32 v137, v137
    v_rcp_f32 v138, v138
    v_rcp_f32 v139, v139
    v_rcp_f32 v140, v140
    v_rcp_f32 v141, v141
    v_rcp_f32 v142, v142
    v_rcp_f32 v143, v143
    v_rcp_f32 v144, v144
    v_rcp_f32 v145, v145
    v_rcp_f32 v146, v146
    v_rcp_f32 v147, v147
    v_rcp_f32 v148, v148
    v_rcp_f32 v149, v149
    v_rcp_f32 v150, v150
    v_rcp_f32 v151, v151
    v_mul_f32 v168, v168, v136
    v_mul_f32 v169, v169, v137
    v_mul_f32 v170, v170, v138
    v_mul_f32 v171, v171, v139
    v_mul_f32 v172, v172, v140
    v_mul_f32 v173, v173, v141
    v_mul_f32 v174, v174, v142
    v_mul_f32 v175, v175, v143
    v_mul_f32 v176, v176, v144
    v_mul_f32 v177, v177, v145
    v_mul_f32 v178, v178, v146
    v_mul_f32 v179, v179, v147
    v_mul_f32 v180, v180, v148
    v_mul_f32 v181, v181, v149
    v_mul_f32 v182, v182, v150
    v_mul_f32 v183, v183, v151
    v_cvt_pk_bf16_f32 v36, v168, v169
    v_cvt_pk_bf16_f32 v37, v170, v171
    v_cvt_pk_bf16_f32 v38, v176, v177
    v_cvt_pk_bf16_f32 v39, v178, v179
    buffer_store_dwordx4 v[36:39], v24, s[12:15], s37 offen offset:0 sc1
    v_cvt_pk_bf16_f32 v40, v172, v173
    v_cvt_pk_bf16_f32 v41, v174, v175
    v_cvt_pk_bf16_f32 v42, v180, v181
    v_cvt_pk_bf16_f32 v43, v182, v183
    buffer_store_dwordx4 v[40:43], v24, s[12:15], s37 offen offset:512 sc1
    v_mul_f32 v88, s24, v88
    v_mul_f32 v89, s24, v89
    v_mul_f32 v90, s24, v90
    v_mul_f32 v91, s24, v91
    v_mul_f32 v92, s24, v92
    v_mul_f32 v93, s24, v93
    v_mul_f32 v94, s24, v94
    v_mul_f32 v95, s24, v95
    v_mul_f32 v96, s24, v96
    v_mul_f32 v97, s24, v97
    v_mul_f32 v98, s24, v98
    v_mul_f32 v99, s24, v99
    v_mul_f32 v100, s24, v100
    v_mul_f32 v101, s24, v101
    v_mul_f32 v102, s24, v102
    v_mul_f32 v103, s24, v103
    v_exp_f32 v88, v88
    v_exp_f32 v89, v89
    v_exp_f32 v90, v90
    v_exp_f32 v91, v91
    v_exp_f32 v92, v92
    v_exp_f32 v93, v93
    v_exp_f32 v94, v94
    v_exp_f32 v95, v95
    v_exp_f32 v96, v96
    v_exp_f32 v97, v97
    v_exp_f32 v98, v98
    v_exp_f32 v99, v99
    v_exp_f32 v100, v100
    v_exp_f32 v101, v101
    v_exp_f32 v102, v102
    v_exp_f32 v103, v103
    v_add_f32 v88, 1.0, v88
    v_add_f32 v89, 1.0, v89
    v_add_f32 v90, 1.0, v90
    v_add_f32 v91, 1.0, v91
    v_add_f32 v92, 1.0, v92
    v_add_f32 v93, 1.0, v93
    v_add_f32 v94, 1.0, v94
    v_add_f32 v95, 1.0, v95
    v_add_f32 v96, 1.0, v96
    v_add_f32 v97, 1.0, v97
    v_add_f32 v98, 1.0, v98
    v_add_f32 v99, 1.0, v99
    v_add_f32 v100, 1.0, v100
    v_add_f32 v101, 1.0, v101
    v_add_f32 v102, 1.0, v102
    v_add_f32 v103, 1.0, v103
    v_rcp_f32 v88, v88
    v_rcp_f32 v89, v89
    v_rcp_f32 v90, v90
    v_rcp_f32 v91, v91
    v_rcp_f32 v92, v92
    v_rcp_f32 v93, v93
    v_rcp_f32 v94, v94
    v_rcp_f32 v95, v95
    v_rcp_f32 v96, v96
    v_rcp_f32 v97, v97
    v_rcp_f32 v98, v98
    v_rcp_f32 v99, v99
    v_rcp_f32 v100, v100
    v_rcp_f32 v101, v101
    v_rcp_f32 v102, v102
    v_rcp_f32 v103, v103
    v_mul_f32 v120, v120, v88
    v_mul_f32 v121, v121, v89
    v_mul_f32 v122, v122, v90
    v_mul_f32 v123, v123, v91
    v_mul_f32 v124, v124, v92
    v_mul_f32 v125, v125, v93
    v_mul_f32 v126, v126, v94
    v_mul_f32 v127, v127, v95
    v_mul_f32 v128, v128, v96
    v_mul_f32 v129, v129, v97
    v_mul_f32 v130, v130, v98
    v_mul_f32 v131, v131, v99
    v_mul_f32 v132, v132, v100
    v_mul_f32 v133, v133, v101
    v_mul_f32 v134, v134, v102
    v_mul_f32 v135, v135, v103
    v_cvt_pk_bf16_f32 v28, v120, v121
    v_cvt_pk_bf16_f32 v29, v122, v123
    v_cvt_pk_bf16_f32 v30, v128, v129
    v_cvt_pk_bf16_f32 v31, v130, v131
    buffer_store_dwordx4 v[28:31], v24, s[12:15], s36 offen offset:1024 sc1
    v_cvt_pk_bf16_f32 v32, v124, v125
    v_cvt_pk_bf16_f32 v33, v126, v127
    v_cvt_pk_bf16_f32 v34, v132, v133
    v_cvt_pk_bf16_f32 v35, v134, v135
    buffer_store_dwordx4 v[32:35], v24, s[12:15], s36 offen offset:1536 sc1
    v_mul_f32 v152, s24, v152
    v_mul_f32 v153, s24, v153
    v_mul_f32 v154, s24, v154
    v_mul_f32 v155, s24, v155
    v_mul_f32 v156, s24, v156
    v_mul_f32 v157, s24, v157
    v_mul_f32 v158, s24, v158
    v_mul_f32 v159, s24, v159
    v_mul_f32 v160, s24, v160
    v_mul_f32 v161, s24, v161
    v_mul_f32 v162, s24, v162
    v_mul_f32 v163, s24, v163
    v_mul_f32 v164, s24, v164
    v_mul_f32 v165, s24, v165
    v_mul_f32 v166, s24, v166
    v_mul_f32 v167, s24, v167
    v_exp_f32 v152, v152
    v_exp_f32 v153, v153
    v_exp_f32 v154, v154
    v_exp_f32 v155, v155
    v_exp_f32 v156, v156
    v_exp_f32 v157, v157
    v_exp_f32 v158, v158
    v_exp_f32 v159, v159
    v_exp_f32 v160, v160
    v_exp_f32 v161, v161
    v_exp_f32 v162, v162
    v_exp_f32 v163, v163
    v_exp_f32 v164, v164
    v_exp_f32 v165, v165
    v_exp_f32 v166, v166
    v_exp_f32 v167, v167
    v_add_f32 v152, 1.0, v152
    v_add_f32 v153, 1.0, v153
    v_add_f32 v154, 1.0, v154
    v_add_f32 v155, 1.0, v155
    v_add_f32 v156, 1.0, v156
    v_add_f32 v157, 1.0, v157
    v_add_f32 v158, 1.0, v158
    v_add_f32 v159, 1.0, v159
    v_add_f32 v160, 1.0, v160
    v_add_f32 v161, 1.0, v161
    v_add_f32 v162, 1.0, v162
    v_add_f32 v163, 1.0, v163
    v_add_f32 v164, 1.0, v164
    v_add_f32 v165, 1.0, v165
    v_add_f32 v166, 1.0, v166
    v_add_f32 v167, 1.0, v167
    v_rcp_f32 v152, v152
    v_rcp_f32 v153, v153
    v_rcp_f32 v154, v154
    v_rcp_f32 v155, v155
    v_rcp_f32 v156, v156
    v_rcp_f32 v157, v157
    v_rcp_f32 v158, v158
    v_rcp_f32 v159, v159
    v_rcp_f32 v160, v160
    v_rcp_f32 v161, v161
    v_rcp_f32 v162, v162
    v_rcp_f32 v163, v163
    v_rcp_f32 v164, v164
    v_rcp_f32 v165, v165
    v_rcp_f32 v166, v166
    v_rcp_f32 v167, v167
    v_mul_f32 v184, v184, v152
    v_mul_f32 v185, v185, v153
    v_mul_f32 v186, v186, v154
    v_mul_f32 v187, v187, v155
    v_mul_f32 v188, v188, v156
    v_mul_f32 v189, v189, v157
    v_mul_f32 v190, v190, v158
    v_mul_f32 v191, v191, v159
    v_mul_f32 v192, v192, v160
    v_mul_f32 v193, v193, v161
    v_mul_f32 v194, v194, v162
    v_mul_f32 v195, v195, v163
    v_mul_f32 v196, v196, v164
    v_mul_f32 v197, v197, v165
    v_mul_f32 v198, v198, v166
    v_mul_f32 v199, v199, v167
    v_cvt_pk_bf16_f32 v36, v184, v185
    v_cvt_pk_bf16_f32 v37, v186, v187
    v_cvt_pk_bf16_f32 v38, v192, v193
    v_cvt_pk_bf16_f32 v39, v194, v195
    buffer_store_dwordx4 v[36:39], v24, s[12:15], s37 offen offset:1024 sc1
    v_cvt_pk_bf16_f32 v40, v188, v189
    v_cvt_pk_bf16_f32 v41, v190, v191
    v_cvt_pk_bf16_f32 v42, v196, v197
    v_cvt_pk_bf16_f32 v43, v198, v199
    buffer_store_dwordx4 v[40:43], v24, s[12:15], s37 offen offset:1536 sc1
    s_setprio 0
L_b_noepi:
    s_waitcnt vmcnt(0)
    s_mov_b32 s59, 0
L_b_n1_nl:
    v_readfirstlane_b32 s60, v2
    v_readfirstlane_b32 s61, v3
    s_nop 1
    s_min_u32 s58, s60, s61
    s_cmp_lg_u32 s58, 0
    s_cbranch_scc1 L_b_n1_nd
    s_add_u32 s59, s59, 1
    s_cmp_ge_u32 s59, 0x20000
    s_cbranch_scc1 L_b_n1_nd
    s_sleep 4
    buffer_load_dwordx2 v[2:3], v4, s[48:51], 0 offen sc1
    s_waitcnt vmcnt(0)
    s_branch L_b_n1_nl
L_b_n1_nd:
    s_lshl_b32 s38, s30, 5
    s_add_u32 s38, s38, s31
    s_lshl_b32 s38, s38, 3
    s_add_u32 s38, s38, 7884800
    s_waitcnt vmcnt(0)
    s_barrier
    s_cmp_eq_u32 s16, 0
    s_cbranch_scc0 L_b_f_fs
    v_mov_b32 v4, s60
    v_mov_b32 v5, s61
    v_mov_b32 v6, 0
    s_mov_b64 s[58:59], exec
    s_mov_b64 exec, 1
    buffer_store_dwordx2 v[4:5], v6, s[12:15], s38 offen sc1
    s_mov_b64 exec, s[58:59]
L_b_f_fs:
L_b_done:
    s_branch L_pend
L_role_c:
    s_load_dwordx2 s[40:41], s[0:1], 48
    s_load_dwordx2 s[42:43], s[0:1], 16
    s_load_dwordx2 s[44:45], s[0:1], 80
    s_load_dwordx2 s[46:47], s[0:1], 64
    s_load_dwordx2 s[56:57], s[0:1], 72
    s_waitcnt lgkmcnt(0)
    s_mov_b32 s4, s40
    s_and_b32 s5, s41, 0xffff
    s_mov_b32 s6, 2211840
    s_mov_b32 s7, 0x20000
    s_mov_b32 s8, s42
    s_and_b32 s9, s43, 0xffff
    s_mov_b32 s10, 819200
    s_mov_b32 s11, 0x20000
    s_mov_b32 s12, s44
    s_and_b32 s13, s45, 0xffff
    s_mov_b32 s14, 268435456
    s_mov_b32 s15, 0x20000
    s_mov_b32 s52, s46
    s_and_b32 s53, s47, 0xffff
    s_mov_b32 s54, 2621440
    s_mov_b32 s55, 0x20000
    s_mov_b32 s48, s56
    s_and_b32 s49, s57, 0xffff
    s_mov_b32 s50, 256
    s_mov_b32 s51, 0x20000
    s_setprio 0
    s_sub_u32 s22, s2, 512
    s_and_b32 s30, s22, 7
    s_lshl_b32 s30, s30, 2
    s_lshr_b32 s32, s22, 6
    s_add_u32 s30, s30, s32
    s_bfe_u32 s31, s22, 0x30003
    v_and_b32 v1, 63, v0
    v_lshrrev_b32 v2, 6, v0
    s_nop 0
    v_readfirstlane_b32 s16, v2
    v_mov_b32 v22, 0
    buffer_load_dwordx2 v[20:21], v22, s[48:51], 0 offen sc1
    v_lshlrev_b32 v13, 4, v1
    v_add_u32 v2, 0, v1
    v_mul_u32_u24 v3, 205, v2
    v_lshrrev_b32 v3, 11, v3
    v_mul_u32_u24 v4, 10, v3
    v_sub_u32 v4, v2, v4
    v_mul_u32_u24 v3, 1280, v3
    v_lshl_add_u32 v3, v4, 4, v3
    v_subrev_u32 v8, 0, v3
    v_add_u32 v2, 64, v1
    v_mul_u32_u24 v3, 205, v2
    v_lshrrev_b32 v3, 11, v3
    v_mul_u32_u24 v4, 10, v3
    v_sub_u32 v4, v2, v4
    v_mul_u32_u24 v3, 1280, v3
    v_lshl_add_u32 v3, v4, 4, v3
    v_subrev_u32 v9, 1024, v3
    v_add_u32 v2, 128, v1
    v_mul_u32_u24 v3, 205, v2
    v_lshrrev_b32 v3, 11, v3
    v_mul_u32_u24 v4, 10, v3
    v_sub_u32 v4, v2, v4
    v_mul_u32_u24 v3, 1280, v3
    v_lshl_add_u32 v3, v4, 4, v3
    v_subrev_u32 v10, 2048, v3
    v_add_u32 v2, 192, v1
    v_mul_u32_u24 v3, 205, v2
    v_lshrrev_b32 v3, 11, v3
    v_mul_u32_u24 v4, 10, v3
    v_sub_u32 v4, v2, v4
    v_mul_u32_u24 v3, 1280, v3
    v_lshl_add_u32 v3, v4, 4, v3
    v_subrev_u32 v11, 3072, v3
    v_add_u32 v2, 256, v1
    v_mul_u32_u24 v3, 205, v2
    v_lshrrev_b32 v3, 11, v3
    v_mul_u32_u24 v4, 10, v3
    v_sub_u32 v4, v2, v4
    v_mul_u32_u24 v3, 1280, v3
    v_lshl_add_u32 v3, v4, 4, v3
    v_mov_b32 v12, v3
    v_lshrrev_b32 v2, 4, v1
    v_bfe_u32 v3, v1, 2, 2
    v_lshl_add_u32 v2, v2, 2, v3
    v_mul_u32_u24 v2, 160, v2
    v_and_b32 v3, 3, v1
    v_lshl_add_u32 v2, v3, 3, v2
    s_mul_i32 s17, s16, 20480
    v_add_u32 v14, s17, v2
    s_cmp_lt_u32 s16, 2
    s_cselect_b32 s19, 14, 13
    s_mul_i32 s20, s16, 14
    s_cmp_eq_u32 s16, 3
    s_cselect_b32 s21, 1, 0
    s_sub_u32 s20, s20, s21
    s_mul_i32 s23, s30, 303104
    s_add_u32 s23, s23, 7929856
    s_mul_i32 s24, s31, 160
    s_lshl_b32 s25, s20, 10
    s_add_u32 s25, s25, s23
    s_mul_i32 s26, s20, 40960
    s_add_u32 s26, s26, s24
    s_mov_b32 s27, s17
    s_add_u32 s29, s17, 20480
    s_add_u32 s33, s16, 0
    s_and_b32 s33, s33, 3
    s_mul_i32 s36, s33, 75776
    s_add_u32 s33, s16, 1
    s_and_b32 s33, s33, 3
    s_mul_i32 s37, s33, 75776
    s_add_u32 s33, s16, 2
    s_and_b32 s33, s33, 3
    s_mul_i32 s38, s33, 75776
    s_add_u32 s33, s16, 3
    s_and_b32 s33, s33, 3
    s_mul_i32 s39, s33, 75776
    s_lshr_b32 s33, s22, 3
    s_lshl_b32 s33, s33, 2
    s_add_u32 s33, s33, s16
    s_mul_i32 s33, s33, 6400
    v_min_u32 v2, 49, v1
    v_lshlrev_b32 v2, 7, v2
    buffer_load_dword v239, v2, s[8:11], s33 offen
    s_lshr_b32 s33, s30, 1
    s_lshl_b32 s34, s33, 8
    s_add_u32 s34, s34, 7884800
    v_min_u32 v28, 13, v1
    v_lshlrev_b32 v28, 3, v28
    v_add_u32 v28, s34, v28
    s_lshl_b32 s33, s33, 3
    s_add_u32 s33, s33, 26216320
    s_and_b32 s34, s2, 15
    s_lshl_b32 s34, s34, 11
    s_add_u32 s33, s33, s34
    v_mov_b32 v29, s33
    v_cmp_eq_u32 vcc, 63, v1
    s_nop 1
    v_cndmask_b32 v28, v28, v29, vcc
    s_cmp_eq_u32 s16, 0
    s_cbranch_scc0 L_c_hfd
    s_mov_b32 s59, 0
L_c_hfw:
    buffer_load_dwordx2 v[24:25], v28, s[12:15], 0 offen sc1
    s_waitcnt vmcnt(0)
    v_readfirstlane_b32 s60, v20
    v_readfirstlane_b32 s61, v21
    s_nop 1
    s_min_u32 s58, s60, s61
    s_cmp_eq_u32 s58, 0
    s_cbranch_scc1 L_c_hre
    v_cmp_ne_u64 vcc, s[60:61], v[24:25]
    s_cmp_eq_u64 vcc, 0
    s_cbranch_scc1 L_c_hfd
L_c_hre:
    s_add_u32 s59, s59, 1
    s_cmp_ge_u32 s59, 0x20000
    s_cbranch_scc1 L_c_hfd
    s_sleep 16
    buffer_load_dwordx2 v[20:21], v22, s[48:51], 0 offen sc1
    s_branch L_c_hfw
L_c_hfd:
    s_barrier
    s_waitcnt vmcnt(0)
    s_mov_b32 s59, 0
L_c_n_nl:
    v_readfirstlane_b32 s60, v20
    v_readfirstlane_b32 s61, v21
    s_nop 1
    s_min_u32 s58, s60, s61
    s_cmp_lg_u32 s58, 0
    s_cbranch_scc1 L_c_n_nd
    s_add_u32 s59, s59, 1
    s_cmp_ge_u32 s59, 0x20000
    s_cbranch_scc1 L_c_n_nd
    s_sleep 4
    buffer_load_dwordx2 v[20:21], v22, s[48:51], 0 offen sc1
    s_waitcnt vmcnt(0)
    s_branch L_c_n_nl
L_c_n_nd:
    s_mov_b32 m0, s27
    s_nop 0
    buffer_load_dwordx4 v8, s[4:7], s26 offen offset:0 lds
    buffer_load_dwordx4 v9, s[4:7], s26 offen offset:1024 lds
    buffer_load_dwordx4 v10, s[4:7], s26 offen offset:2048 lds
    buffer_load_dwordx4 v11, s[4:7], s26 offen offset:3072 lds
    s_add_u32 m0, s27, 4096
    s_add_u32 s27, s27, 5120
    buffer_load_dwordx4 v12, s[4:7], s26 offen lds
    s_add_u32 s26, s26, 40960
    s_cmp_ge_u32 s27, s29
    s_cselect_b32 s27, s17, s27
    s_mov_b32 m0, s27
    s_nop 0
    buffer_load_dwordx4 v8, s[4:7], s26 offen offset:0 lds
    buffer_load_dwordx4 v9, s[4:7], s26 offen offset:1024 lds
    buffer_load_dwordx4 v10, s[4:7], s26 offen offset:2048 lds
    buffer_load_dwordx4 v11, s[4:7], s26 offen offset:3072 lds
    s_add_u32 m0, s27, 4096
    s_add_u32 s27, s27, 5120
    buffer_load_dwordx4 v12, s[4:7], s26 offen lds
    s_add_u32 s26, s26, 40960
    s_cmp_ge_u32 s27, s29
    s_cselect_b32 s27, s17, s27
    s_mov_b32 m0, s27
    s_nop 0
    buffer_load_dwordx4 v8, s[4:7], s26 offen offset:0 lds
    buffer_load_dwordx4 v9, s[4:7], s26 offen offset:1024 lds
    buffer_load_dwordx4 v10, s[4:7], s26 offen offset:2048 lds
    buffer_load_dwordx4 v11, s[4:7], s26 offen offset:3072 lds
    s_add_u32 m0, s27, 4096
    s_add_u32 s27, s27, 5120
    buffer_load_dwordx4 v12, s[4:7], s26 offen lds
    s_add_u32 s26, s26, 40960
    s_cmp_ge_u32 s27, s29
    s_cselect_b32 s27, s17, s27
    v_and_b32 v2, 15, v1
    v_lshlrev_b32 v2, 2, v2
    s_lshl_b32 s18, s30, 8
    s_lshl_b32 s33, s16, 6
    s_add_u32 s18, s18, s33
    s_add_u32 s18, s18, 7864320
    buffer_load_dword v15, v2, s[12:15], s18 offen sc1
    s_add_u32 s33, s25, s36
    buffer_load_dwordx4 v[20:23], v13, s[12:15], s33 offen sc1
    s_add_u32 s33, s25, s37
    buffer_load_dwordx4 v[24:27], v13, s[12:15], s33 offen sc1
    s_add_u32 s33, s25, s38
    buffer_load_dwordx4 v[28:31], v13, s[12:15], s33 offen sc1
    s_add_u32 s33, s25, s39
    buffer_load_dwordx4 v[32:35], v13, s[12:15], s33 offen sc1
    s_add_u32 s25, s25, 1024
    s_add_u32 s33, s25, s36
    buffer_load_dwordx4 v[36:39], v13, s[12:15], s33 offen sc1
    s_add_u32 s33, s25, s37
    buffer_load_dwordx4 v[40:43], v13, s[12:15], s33 offen sc1
    s_add_u32 s33, s25, s38
    buffer_load_dwordx4 v[44:47], v13, s[12:15], s33 offen sc1
    s_add_u32 s33, s25, s39
    buffer_load_dwordx4 v[48:51], v13, s[12:15], s33 offen sc1
    s_add_u32 s25, s25, 1024
    s_add_u32 s33, s25, s36
    buffer_load_dwordx4 v[52:55], v13, s[12:15], s33 offen sc1
    s_add_u32 s33, s25, s37
    buffer_load_dwordx4 v[56:59], v13, s[12:15], s33 offen sc1
    s_add_u32 s33, s25, s38
    buffer_load_dwordx4 v[60:63], v13, s[12:15], s33 offen sc1
    s_add_u32 s33, s25, s39
    buffer_load_dwordx4 v[64:67], v13, s[12:15], s33 offen sc1
    s_add_u32 s25, s25, 1024
    v_mov_b32 v140, 0
    v_mov_b32 v141, 0
    v_mov_b32 v142, 0
    v_mov_b32 v143, 0
    v_mov_b32 v144, 0
    v_mov_b32 v145, 0
    v_mov_b32 v146, 0
    v_mov_b32 v147, 0
    v_mov_b32 v148, 0
    v_mov_b32 v149, 0
    v_mov_b32 v150, 0
    v_mov_b32 v151, 0
    v_mov_b32 v152, 0
    v_mov_b32 v153, 0
    v_mov_b32 v154, 0
    v_mov_b32 v155, 0
    v_mov_b32 v156, 0
    v_mov_b32 v157, 0
    v_mov_b32 v158, 0
    v_mov_b32 v159, 0
    v_mov_b32 v160, 0
    v_mov_b32 v161, 0
    v_mov_b32 v162, 0
    v_mov_b32 v163, 0
    v_mov_b32 v164, 0
    v_mov_b32 v165, 0
    v_mov_b32 v166, 0
    v_mov_b32 v167, 0
    v_mov_b32 v168, 0
    v_mov_b32 v169, 0
    v_mov_b32 v170, 0
    v_mov_b32 v171, 0
    v_mov_b32 v172, 0
    v_mov_b32 v173, 0
    v_mov_b32 v174, 0
    v_mov_b32 v175, 0
    v_mov_b32 v176, 0
    v_mov_b32 v177, 0
    v_mov_b32 v178, 0
    v_mov_b32 v179, 0
    v_mov_b32 v180, 0
    v_mov_b32 v181, 0
    v_mov_b32 v182, 0
    v_mov_b32 v183, 0
    v_mov_b32 v184, 0
    v_mov_b32 v185, 0
    v_mov_b32 v186, 0
    v_mov_b32 v187, 0
    v_mov_b32 v188, 0
    v_mov_b32 v189, 0
    v_mov_b32 v190, 0
    v_mov_b32 v191, 0
    v_mov_b32 v192, 0
    v_mov_b32 v193, 0
    v_mov_b32 v194, 0
    v_mov_b32 v195, 0
    v_mov_b32 v196, 0
    v_mov_b32 v197, 0
    v_mov_b32 v198, 0
    v_mov_b32 v199, 0
    v_mov_b32 v200, 0
    v_mov_b32 v201, 0
    v_mov_b32 v202, 0
    v_mov_b32 v203, 0
    v_mov_b32 v204, 0
    v_mov_b32 v205, 0
    v_mov_b32 v206, 0
    v_mov_b32 v207, 0
    v_mov_b32 v208, 0
    v_mov_b32 v209, 0
    v_mov_b32 v210, 0
    v_mov_b32 v211, 0
    v_mov_b32 v212, 0
    v_mov_b32 v213, 0
    v_mov_b32 v214, 0
    v_mov_b32 v215, 0
    v_mov_b32 v216, 0
    v_mov_b32 v217, 0
    v_mov_b32 v218, 0
    v_mov_b32 v219, 0
    s_mov_b32 s34, 0
    s_mov_b32 s35, 0
    s_waitcnt vmcnt(8)
    v_add_u32 v2, s34, v14
    ds_read_b64_tr_b16 v[100:101], v2 offset:0
    ds_read_b64_tr_b16 v[102:103], v2 offset:2560
    ds_read_b64_tr_b16 v[104:105], v2 offset:32
    ds_read_b64_tr_b16 v[106:107], v2 offset:2592
    ds_read_b64_tr_b16 v[108:109], v2 offset:64
    ds_read_b64_tr_b16 v[110:111], v2 offset:2624
    ds_read_b64_tr_b16 v[112:113], v2 offset:96
    ds_read_b64_tr_b16 v[114:115], v2 offset:2656
    ds_read_b64_tr_b16 v[116:117], v2 offset:128
    ds_read_b64_tr_b16 v[118:119], v2 offset:2688
    s_add_u32 s34, s34, 5120
    s_cmp_eq_u32 s34, 20480
    s_cselect_b32 s34, 0, s34
    s_setprio 0
.p2align 4
L_c_loop:
    s_add_u32 s33, s35, 3
    s_cmp_lt_u32 s33, s19
    s_cbranch_scc0 L_c_t0
    s_waitcnt vmcnt(13) lgkmcnt(0)
    v_add_u32 v2, s34, v14
    v_mfma_f32_16x16x32_bf16 v[140:143], v[100:103], v[20:23], v[140:143]
    ds_read_b64_tr_b16 v[120:121], v2 offset:0
    v_mfma_f32_16x16x32_bf16 v[160:163], v[100:103], v[24:27], v[160:163]
    ds_read_b64_tr_b16 v[122:123], v2 offset:2560
    v_mfma_f32_16x16x32_bf16 v[180:183], v[100:103], v[28:31], v[180:183]
    ds_read_b64_tr_b16 v[124:125], v2 offset:32
    v_mfma_f32_16x16x32_bf16 v[200:203], v[100:103], v[32:35], v[200:203]
    ds_read_b64_tr_b16 v[126:127], v2 offset:2592
    v_mfma_f32_16x16x32_bf16 v[144:147], v[104:107], v[20:23], v[144:147]
    ds_read_b64_tr_b16 v[128:129], v2 offset:64
    v_mfma_f32_16x16x32_bf16 v[164:167], v[104:107], v[24:27], v[164:167]
    ds_read_b64_tr_b16 v[130:131], v2 offset:2624
    v_mfma_f32_16x16x32_bf16 v[184:187], v[104:107], v[28:31], v[184:187]
    ds_read_b64_tr_b16 v[132:133], v2 offset:96
    v_mfma_f32_16x16x32_bf16 v[204:207], v[104:107], v[32:35], v[204:207]
    ds_read_b64_tr_b16 v[134:135], v2 offset:2656
    v_mfma_f32_16x16x32_bf16 v[148:151], v[108:111], v[20:23], v[148:151]
    ds_read_b64_tr_b16 v[136:137], v2 offset:128
    v_mfma_f32_16x16x32_bf16 v[168:171], v[108:111], v[24:27], v[168:171]
    ds_read_b64_tr_b16 v[138:139], v2 offset:2688
    v_mfma_f32_16x16x32_bf16 v[188:191], v[108:111], v[28:31], v[188:191]
    s_mov_b32 m0, s27
    v_mfma_f32_16x16x32_bf16 v[208:211], v[108:111], v[32:35], v[208:211]
    s_nop 0
    v_mfma_f32_16x16x32_bf16 v[152:155], v[112:115], v[20:23], v[152:155]
    buffer_load_dwordx4 v8, s[4:7], s26 offen offset:0 lds
    v_mfma_f32_16x16x32_bf16 v[172:175], v[112:115], v[24:27], v[172:175]
    buffer_load_dwordx4 v9, s[4:7], s26 offen offset:1024 lds
    v_mfma_f32_16x16x32_bf16 v[192:195], v[112:115], v[28:31], v[192:195]
    buffer_load_dwordx4 v10, s[4:7], s26 offen offset:2048 lds
    v_mfma_f32_16x16x32_bf16 v[212:215], v[112:115], v[32:35], v[212:215]
    buffer_load_dwordx4 v11, s[4:7], s26 offen offset:3072 lds
    v_mfma_f32_16x16x32_bf16 v[156:159], v[116:119], v[20:23], v[156:159]
    s_add_u32 m0, s27, 4096
    v_mfma_f32_16x16x32_bf16 v[176:179], v[116:119], v[24:27], v[176:179]
    s_add_u32 s27, s27, 5120
    v_mfma_f32_16x16x32_bf16 v[196:199], v[116:119], v[28:31], v[196:199]
    buffer_load_dwordx4 v12, s[4:7], s26 offen lds
    v_mfma_f32_16x16x32_bf16 v[216:219], v[116:119], v[32:35], v[216:219]
    s_add_u32 s26, s26, 40960
    s_cmp_ge_u32 s27, s29
    s_cselect_b32 s27, s17, s27
    s_add_u32 s33, s25, s36
    buffer_load_dwordx4 v[68:71], v13, s[12:15], s33 offen sc1
    s_add_u32 s33, s25, s37
    buffer_load_dwordx4 v[72:75], v13, s[12:15], s33 offen sc1
    s_add_u32 s33, s25, s38
    buffer_load_dwordx4 v[76:79], v13, s[12:15], s33 offen sc1
    s_add_u32 s33, s25, s39
    buffer_load_dwordx4 v[80:83], v13, s[12:15], s33 offen sc1
    s_add_u32 s25, s25, 1024
    s_add_u32 s34, s34, 5120
    s_cmp_eq_u32 s34, 20480
    s_cselect_b32 s34, 0, s34
    s_branch L_c_n0
L_c_t0:
    s_waitcnt vmcnt(0) lgkmcnt(0)
    v_add_u32 v2, s34, v14
    v_mfma_f32_16x16x32_bf16 v[140:143], v[100:103], v[20:23], v[140:143]
    ds_read_b64_tr_b16 v[120:121], v2 offset:0
    v_mfma_f32_16x16x32_bf16 v[160:163], v[100:103], v[24:27], v[160:163]
    ds_read_b64_tr_b16 v[122:123], v2 offset:2560
    v_mfma_f32_16x16x32_bf16 v[180:183], v[100:103], v[28:31], v[180:183]
    ds_read_b64_tr_b16 v[124:125], v2 offset:32
    v_mfma_f32_16x16x32_bf16 v[200:203], v[100:103], v[32:35], v[200:203]
    ds_read_b64_tr_b16 v[126:127], v2 offset:2592
    v_mfma_f32_16x16x32_bf16 v[144:147], v[104:107], v[20:23], v[144:147]
    ds_read_b64_tr_b16 v[128:129], v2 offset:64
    v_mfma_f32_16x16x32_bf16 v[164:167], v[104:107], v[24:27], v[164:167]
    ds_read_b64_tr_b16 v[130:131], v2 offset:2624
    v_mfma_f32_16x16x32_bf16 v[184:187], v[104:107], v[28:31], v[184:187]
    ds_read_b64_tr_b16 v[132:133], v2 offset:96
    v_mfma_f32_16x16x32_bf16 v[204:207], v[104:107], v[32:35], v[204:207]
    ds_read_b64_tr_b16 v[134:135], v2 offset:2656
    v_mfma_f32_16x16x32_bf16 v[148:151], v[108:111], v[20:23], v[148:151]
    ds_read_b64_tr_b16 v[136:137], v2 offset:128
    v_mfma_f32_16x16x32_bf16 v[168:171], v[108:111], v[24:27], v[168:171]
    ds_read_b64_tr_b16 v[138:139], v2 offset:2688
    v_mfma_f32_16x16x32_bf16 v[188:191], v[108:111], v[28:31], v[188:191]
    v_mfma_f32_16x16x32_bf16 v[208:211], v[108:111], v[32:35], v[208:211]
    v_mfma_f32_16x16x32_bf16 v[152:155], v[112:115], v[20:23], v[152:155]
    v_mfma_f32_16x16x32_bf16 v[172:175], v[112:115], v[24:27], v[172:175]
    v_mfma_f32_16x16x32_bf16 v[192:195], v[112:115], v[28:31], v[192:195]
    v_mfma_f32_16x16x32_bf16 v[212:215], v[112:115], v[32:35], v[212:215]
    v_mfma_f32_16x16x32_bf16 v[156:159], v[116:119], v[20:23], v[156:159]
    v_mfma_f32_16x16x32_bf16 v[176:179], v[116:119], v[24:27], v[176:179]
    v_mfma_f32_16x16x32_bf16 v[196:199], v[116:119], v[28:31], v[196:199]
    v_mfma_f32_16x16x32_bf16 v[216:219], v[116:119], v[32:35], v[216:219]
    s_add_u32 s34, s34, 5120
    s_cmp_eq_u32 s34, 20480
    s_cselect_b32 s34, 0, s34
L_c_n0:
    s_add_u32 s35, s35, 1
    s_cmp_ge_u32 s35, s19
    s_cbranch_scc1 L_c_hdone
    s_add_u32 s33, s35, 3
    s_cmp_lt_u32 s33, s19
    s_cbranch_scc0 L_c_t1
    s_waitcnt vmcnt(13) lgkmcnt(0)
    v_add_u32 v2, s34, v14
    v_mfma_f32_16x16x32_bf16 v[140:143], v[120:123], v[36:39], v[140:143]
    ds_read_b64_tr_b16 v[100:101], v2 offset:0
    v_mfma_f32_16x16x32_bf16 v[160:163], v[120:123], v[40:43], v[160:163]
    ds_read_b64_tr_b16 v[102:103], v2 offset:2560
    v_mfma_f32_16x16x32_bf16 v[180:183], v[120:123], v[44:47], v[180:183]
    ds_read_b64_tr_b16 v[104:105], v2 offset:32
    v_mfma_f32_16x16x32_bf16 v[200:203], v[120:123], v[48:51], v[200:203]
    ds_read_b64_tr_b16 v[106:107], v2 offset:2592
    v_mfma_f32_16x16x32_bf16 v[144:147], v[124:127], v[36:39], v[144:147]
    ds_read_b64_tr_b16 v[108:109], v2 offset:64
    v_mfma_f32_16x16x32_bf16 v[164:167], v[124:127], v[40:43], v[164:167]
    ds_read_b64_tr_b16 v[110:111], v2 offset:2624
    v_mfma_f32_16x16x32_bf16 v[184:187], v[124:127], v[44:47], v[184:187]
    ds_read_b64_tr_b16 v[112:113], v2 offset:96
    v_mfma_f32_16x16x32_bf16 v[204:207], v[124:127], v[48:51], v[204:207]
    ds_read_b64_tr_b16 v[114:115], v2 offset:2656
    v_mfma_f32_16x16x32_bf16 v[148:151], v[128:131], v[36:39], v[148:151]
    ds_read_b64_tr_b16 v[116:117], v2 offset:128
    v_mfma_f32_16x16x32_bf16 v[168:171], v[128:131], v[40:43], v[168:171]
    ds_read_b64_tr_b16 v[118:119], v2 offset:2688
    v_mfma_f32_16x16x32_bf16 v[188:191], v[128:131], v[44:47], v[188:191]
    s_mov_b32 m0, s27
    v_mfma_f32_16x16x32_bf16 v[208:211], v[128:131], v[48:51], v[208:211]
    s_nop 0
    v_mfma_f32_16x16x32_bf16 v[152:155], v[132:135], v[36:39], v[152:155]
    buffer_load_dwordx4 v8, s[4:7], s26 offen offset:0 lds
    v_mfma_f32_16x16x32_bf16 v[172:175], v[132:135], v[40:43], v[172:175]
    buffer_load_dwordx4 v9, s[4:7], s26 offen offset:1024 lds
    v_mfma_f32_16x16x32_bf16 v[192:195], v[132:135], v[44:47], v[192:195]
    buffer_load_dwordx4 v10, s[4:7], s26 offen offset:2048 lds
    v_mfma_f32_16x16x32_bf16 v[212:215], v[132:135], v[48:51], v[212:215]
    buffer_load_dwordx4 v11, s[4:7], s26 offen offset:3072 lds
    v_mfma_f32_16x16x32_bf16 v[156:159], v[136:139], v[36:39], v[156:159]
    s_add_u32 m0, s27, 4096
    v_mfma_f32_16x16x32_bf16 v[176:179], v[136:139], v[40:43], v[176:179]
    s_add_u32 s27, s27, 5120
    v_mfma_f32_16x16x32_bf16 v[196:199], v[136:139], v[44:47], v[196:199]
    buffer_load_dwordx4 v12, s[4:7], s26 offen lds
    v_mfma_f32_16x16x32_bf16 v[216:219], v[136:139], v[48:51], v[216:219]
    s_add_u32 s26, s26, 40960
    s_cmp_ge_u32 s27, s29
    s_cselect_b32 s27, s17, s27
    s_add_u32 s33, s25, s36
    buffer_load_dwordx4 v[20:23], v13, s[12:15], s33 offen sc1
    s_add_u32 s33, s25, s37
    buffer_load_dwordx4 v[24:27], v13, s[12:15], s33 offen sc1
    s_add_u32 s33, s25, s38
    buffer_load_dwordx4 v[28:31], v13, s[12:15], s33 offen sc1
    s_add_u32 s33, s25, s39
    buffer_load_dwordx4 v[32:35], v13, s[12:15], s33 offen sc1
    s_add_u32 s25, s25, 1024
    s_add_u32 s34, s34, 5120
    s_cmp_eq_u32 s34, 20480
    s_cselect_b32 s34, 0, s34
    s_branch L_c_n1
L_c_t1:
    s_waitcnt vmcnt(0) lgkmcnt(0)
    v_add_u32 v2, s34, v14
    v_mfma_f32_16x16x32_bf16 v[140:143], v[120:123], v[36:39], v[140:143]
    ds_read_b64_tr_b16 v[100:101], v2 offset:0
    v_mfma_f32_16x16x32_bf16 v[160:163], v[120:123], v[40:43], v[160:163]
    ds_read_b64_tr_b16 v[102:103], v2 offset:2560
    v_mfma_f32_16x16x32_bf16 v[180:183], v[120:123], v[44:47], v[180:183]
    ds_read_b64_tr_b16 v[104:105], v2 offset:32
    v_mfma_f32_16x16x32_bf16 v[200:203], v[120:123], v[48:51], v[200:203]
    ds_read_b64_tr_b16 v[106:107], v2 offset:2592
    v_mfma_f32_16x16x32_bf16 v[144:147], v[124:127], v[36:39], v[144:147]
    ds_read_b64_tr_b16 v[108:109], v2 offset:64
    v_mfma_f32_16x16x32_bf16 v[164:167], v[124:127], v[40:43], v[164:167]
    ds_read_b64_tr_b16 v[110:111], v2 offset:2624
    v_mfma_f32_16x16x32_bf16 v[184:187], v[124:127], v[44:47], v[184:187]
    ds_read_b64_tr_b16 v[112:113], v2 offset:96
    v_mfma_f32_16x16x32_bf16 v[204:207], v[124:127], v[48:51], v[204:207]
    ds_read_b64_tr_b16 v[114:115], v2 offset:2656
    v_mfma_f32_16x16x32_bf16 v[148:151], v[128:131], v[36:39], v[148:151]
    ds_read_b64_tr_b16 v[116:117], v2 offset:128
    v_mfma_f32_16x16x32_bf16 v[168:171], v[128:131], v[40:43], v[168:171]
    ds_read_b64_tr_b16 v[118:119], v2 offset:2688
    v_mfma_f32_16x16x32_bf16 v[188:191], v[128:131], v[44:47], v[188:191]
    v_mfma_f32_16x16x32_bf16 v[208:211], v[128:131], v[48:51], v[208:211]
    v_mfma_f32_16x16x32_bf16 v[152:155], v[132:135], v[36:39], v[152:155]
    v_mfma_f32_16x16x32_bf16 v[172:175], v[132:135], v[40:43], v[172:175]
    v_mfma_f32_16x16x32_bf16 v[192:195], v[132:135], v[44:47], v[192:195]
    v_mfma_f32_16x16x32_bf16 v[212:215], v[132:135], v[48:51], v[212:215]
    v_mfma_f32_16x16x32_bf16 v[156:159], v[136:139], v[36:39], v[156:159]
    v_mfma_f32_16x16x32_bf16 v[176:179], v[136:139], v[40:43], v[176:179]
    v_mfma_f32_16x16x32_bf16 v[196:199], v[136:139], v[44:47], v[196:199]
    v_mfma_f32_16x16x32_bf16 v[216:219], v[136:139], v[48:51], v[216:219]
    s_add_u32 s34, s34, 5120
    s_cmp_eq_u32 s34, 20480
    s_cselect_b32 s34, 0, s34
L_c_n1:
    s_add_u32 s35, s35, 1
    s_cmp_ge_u32 s35, s19
    s_cbranch_scc1 L_c_hdone
    s_add_u32 s33, s35, 3
    s_cmp_lt_u32 s33, s19
    s_cbranch_scc0 L_c_t2
    s_waitcnt vmcnt(13) lgkmcnt(0)
    v_add_u32 v2, s34, v14
    v_mfma_f32_16x16x32_bf16 v[140:143], v[100:103], v[52:55], v[140:143]
    ds_read_b64_tr_b16 v[120:121], v2 offset:0
    v_mfma_f32_16x16x32_bf16 v[160:163], v[100:103], v[56:59], v[160:163]
    ds_read_b64_tr_b16 v[122:123], v2 offset:2560
    v_mfma_f32_16x16x32_bf16 v[180:183], v[100:103], v[60:63], v[180:183]
    ds_read_b64_tr_b16 v[124:125], v2 offset:32
    v_mfma_f32_16x16x32_bf16 v[200:203], v[100:103], v[64:67], v[200:203]
    ds_read_b64_tr_b16 v[126:127], v2 offset:2592
    v_mfma_f32_16x16x32_bf16 v[144:147], v[104:107], v[52:55], v[144:147]
    ds_read_b64_tr_b16 v[128:129], v2 offset:64
    v_mfma_f32_16x16x32_bf16 v[164:167], v[104:107], v[56:59], v[164:167]
    ds_read_b64_tr_b16 v[130:131], v2 offset:2624
    v_mfma_f32_16x16x32_bf16 v[184:187], v[104:107], v[60:63], v[184:187]
    ds_read_b64_tr_b16 v[132:133], v2 offset:96
    v_mfma_f32_16x16x32_bf16 v[204:207], v[104:107], v[64:67], v[204:207]
    ds_read_b64_tr_b16 v[134:135], v2 offset:2656
    v_mfma_f32_16x16x32_bf16 v[148:151], v[108:111], v[52:55], v[148:151]
    ds_read_b64_tr_b16 v[136:137], v2 offset:128
    v_mfma_f32_16x16x32_bf16 v[168:171], v[108:111], v[56:59], v[168:171]
    ds_read_b64_tr_b16 v[138:139], v2 offset:2688
    v_mfma_f32_16x16x32_bf16 v[188:191], v[108:111], v[60:63], v[188:191]
    s_mov_b32 m0, s27
    v_mfma_f32_16x16x32_bf16 v[208:211], v[108:111], v[64:67], v[208:211]
    s_nop 0
    v_mfma_f32_16x16x32_bf16 v[152:155], v[112:115], v[52:55], v[152:155]
    buffer_load_dwordx4 v8, s[4:7], s26 offen offset:0 lds
    v_mfma_f32_16x16x32_bf16 v[172:175], v[112:115], v[56:59], v[172:175]
    buffer_load_dwordx4 v9, s[4:7], s26 offen offset:1024 lds
    v_mfma_f32_16x16x32_bf16 v[192:195], v[112:115], v[60:63], v[192:195]
    buffer_load_dwordx4 v10, s[4:7], s26 offen offset:2048 lds
    v_mfma_f32_16x16x32_bf16 v[212:215], v[112:115], v[64:67], v[212:215]
    buffer_load_dwordx4 v11, s[4:7], s26 offen offset:3072 lds
    v_mfma_f32_16x16x32_bf16 v[156:159], v[116:119], v[52:55], v[156:159]
    s_add_u32 m0, s27, 4096
    v_mfma_f32_16x16x32_bf16 v[176:179], v[116:119], v[56:59], v[176:179]
    s_add_u32 s27, s27, 5120
    v_mfma_f32_16x16x32_bf16 v[196:199], v[116:119], v[60:63], v[196:199]
    buffer_load_dwordx4 v12, s[4:7], s26 offen lds
    v_mfma_f32_16x16x32_bf16 v[216:219], v[116:119], v[64:67], v[216:219]
    s_add_u32 s26, s26, 40960
    s_cmp_ge_u32 s27, s29
    s_cselect_b32 s27, s17, s27
    s_add_u32 s33, s25, s36
    buffer_load_dwordx4 v[36:39], v13, s[12:15], s33 offen sc1
    s_add_u32 s33, s25, s37
    buffer_load_dwordx4 v[40:43], v13, s[12:15], s33 offen sc1
    s_add_u32 s33, s25, s38
    buffer_load_dwordx4 v[44:47], v13, s[12:15], s33 offen sc1
    s_add_u32 s33, s25, s39
    buffer_load_dwordx4 v[48:51], v13, s[12:15], s33 offen sc1
    s_add_u32 s25, s25, 1024
    s_add_u32 s34, s34, 5120
    s_cmp_eq_u32 s34, 20480
    s_cselect_b32 s34, 0, s34
    s_branch L_c_n2
L_c_t2:
    s_waitcnt vmcnt(0) lgkmcnt(0)
    v_add_u32 v2, s34, v14
    v_mfma_f32_16x16x32_bf16 v[140:143], v[100:103], v[52:55], v[140:143]
    ds_read_b64_tr_b16 v[120:121], v2 offset:0
    v_mfma_f32_16x16x32_bf16 v[160:163], v[100:103], v[56:59], v[160:163]
    ds_read_b64_tr_b16 v[122:123], v2 offset:2560
    v_mfma_f32_16x16x32_bf16 v[180:183], v[100:103], v[60:63], v[180:183]
    ds_read_b64_tr_b16 v[124:125], v2 offset:32
    v_mfma_f32_16x16x32_bf16 v[200:203], v[100:103], v[64:67], v[200:203]
    ds_read_b64_tr_b16 v[126:127], v2 offset:2592
    v_mfma_f32_16x16x32_bf16 v[144:147], v[104:107], v[52:55], v[144:147]
    ds_read_b64_tr_b16 v[128:129], v2 offset:64
    v_mfma_f32_16x16x32_bf16 v[164:167], v[104:107], v[56:59], v[164:167]
    ds_read_b64_tr_b16 v[130:131], v2 offset:2624
    v_mfma_f32_16x16x32_bf16 v[184:187], v[104:107], v[60:63], v[184:187]
    ds_read_b64_tr_b16 v[132:133], v2 offset:96
    v_mfma_f32_16x16x32_bf16 v[204:207], v[104:107], v[64:67], v[204:207]
    ds_read_b64_tr_b16 v[134:135], v2 offset:2656
    v_mfma_f32_16x16x32_bf16 v[148:151], v[108:111], v[52:55], v[148:151]
    ds_read_b64_tr_b16 v[136:137], v2 offset:128
    v_mfma_f32_16x16x32_bf16 v[168:171], v[108:111], v[56:59], v[168:171]
    ds_read_b64_tr_b16 v[138:139], v2 offset:2688
    v_mfma_f32_16x16x32_bf16 v[188:191], v[108:111], v[60:63], v[188:191]
    v_mfma_f32_16x16x32_bf16 v[208:211], v[108:111], v[64:67], v[208:211]
    v_mfma_f32_16x16x32_bf16 v[152:155], v[112:115], v[52:55], v[152:155]
    v_mfma_f32_16x16x32_bf16 v[172:175], v[112:115], v[56:59], v[172:175]
    v_mfma_f32_16x16x32_bf16 v[192:195], v[112:115], v[60:63], v[192:195]
    v_mfma_f32_16x16x32_bf16 v[212:215], v[112:115], v[64:67], v[212:215]
    v_mfma_f32_16x16x32_bf16 v[156:159], v[116:119], v[52:55], v[156:159]
    v_mfma_f32_16x16x32_bf16 v[176:179], v[116:119], v[56:59], v[176:179]
    v_mfma_f32_16x16x32_bf16 v[196:199], v[116:119], v[60:63], v[196:199]
    v_mfma_f32_16x16x32_bf16 v[216:219], v[116:119], v[64:67], v[216:219]
    s_add_u32 s34, s34, 5120
    s_cmp_eq_u32 s34, 20480
    s_cselect_b32 s34, 0, s34
L_c_n2:
    s_add_u32 s35, s35, 1
    s_cmp_ge_u32 s35, s19
    s_cbranch_scc1 L_c_hdone
    s_add_u32 s33, s35, 3
    s_cmp_lt_u32 s33, s19
    s_cbranch_scc0 L_c_t3
    s_waitcnt vmcnt(13) lgkmcnt(0)
    v_add_u32 v2, s34, v14
    v_mfma_f32_16x16x32_bf16 v[140:143], v[120:123], v[68:71], v[140:143]
    ds_read_b64_tr_b16 v[100:101], v2 offset:0
    v_mfma_f32_16x16x32_bf16 v[160:163], v[120:123], v[72:75], v[160:163]
    ds_read_b64_tr_b16 v[102:103], v2 offset:2560
    v_mfma_f32_16x16x32_bf16 v[180:183], v[120:123], v[76:79], v[180:183]
    ds_read_b64_tr_b16 v[104:105], v2 offset:32
    v_mfma_f32_16x16x32_bf16 v[200:203], v[120:123], v[80:83], v[200:203]
    ds_read_b64_tr_b16 v[106:107], v2 offset:2592
    v_mfma_f32_16x16x32_bf16 v[144:147], v[124:127], v[68:71], v[144:147]
    ds_read_b64_tr_b16 v[108:109], v2 offset:64
    v_mfma_f32_16x16x32_bf16 v[164:167], v[124:127], v[72:75], v[164:167]
    ds_read_b64_tr_b16 v[110:111], v2 offset:2624
    v_mfma_f32_16x16x32_bf16 v[184:187], v[124:127], v[76:79], v[184:187]
    ds_read_b64_tr_b16 v[112:113], v2 offset:96
    v_mfma_f32_16x16x32_bf16 v[204:207], v[124:127], v[80:83], v[204:207]
    ds_read_b64_tr_b16 v[114:115], v2 offset:2656
    v_mfma_f32_16x16x32_bf16 v[148:151], v[128:131], v[68:71], v[148:151]
    ds_read_b64_tr_b16 v[116:117], v2 offset:128
    v_mfma_f32_16x16x32_bf16 v[168:171], v[128:131], v[72:75], v[168:171]
    ds_read_b64_tr_b16 v[118:119], v2 offset:2688
    v_mfma_f32_16x16x32_bf16 v[188:191], v[128:131], v[76:79], v[188:191]
    s_mov_b32 m0, s27
    v_mfma_f32_16x16x32_bf16 v[208:211], v[128:131], v[80:83], v[208:211]
    s_nop 0
    v_mfma_f32_16x16x32_bf16 v[152:155], v[132:135], v[68:71], v[152:155]
    buffer_load_dwordx4 v8, s[4:7], s26 offen offset:0 lds
    v_mfma_f32_16x16x32_bf16 v[172:175], v[132:135], v[72:75], v[172:175]
    buffer_load_dwordx4 v9, s[4:7], s26 offen offset:1024 lds
    v_mfma_f32_16x16x32_bf16 v[192:195], v[132:135], v[76:79], v[192:195]
    buffer_load_dwordx4 v10, s[4:7], s26 offen offset:2048 lds
    v_mfma_f32_16x16x32_bf16 v[212:215], v[132:135], v[80:83], v[212:215]
    buffer_load_dwordx4 v11, s[4:7], s26 offen offset:3072 lds
    v_mfma_f32_16x16x32_bf16 v[156:159], v[136:139], v[68:71], v[156:159]
    s_add_u32 m0, s27, 4096
    v_mfma_f32_16x16x32_bf16 v[176:179], v[136:139], v[72:75], v[176:179]
    s_add_u32 s27, s27, 5120
    v_mfma_f32_16x16x32_bf16 v[196:199], v[136:139], v[76:79], v[196:199]
    buffer_load_dwordx4 v12, s[4:7], s26 offen lds
    v_mfma_f32_16x16x32_bf16 v[216:219], v[136:139], v[80:83], v[216:219]
    s_add_u32 s26, s26, 40960
    s_cmp_ge_u32 s27, s29
    s_cselect_b32 s27, s17, s27
    s_add_u32 s33, s25, s36
    buffer_load_dwordx4 v[52:55], v13, s[12:15], s33 offen sc1
    s_add_u32 s33, s25, s37
    buffer_load_dwordx4 v[56:59], v13, s[12:15], s33 offen sc1
    s_add_u32 s33, s25, s38
    buffer_load_dwordx4 v[60:63], v13, s[12:15], s33 offen sc1
    s_add_u32 s33, s25, s39
    buffer_load_dwordx4 v[64:67], v13, s[12:15], s33 offen sc1
    s_add_u32 s25, s25, 1024
    s_add_u32 s34, s34, 5120
    s_cmp_eq_u32 s34, 20480
    s_cselect_b32 s34, 0, s34
    s_branch L_c_n3
L_c_t3:
    s_waitcnt vmcnt(0) lgkmcnt(0)
    v_add_u32 v2, s34, v14
    v_mfma_f32_16x16x32_bf16 v[140:143], v[120:123], v[68:71], v[140:143]
    ds_read_b64_tr_b16 v[100:101], v2 offset:0
    v_mfma_f32_16x16x32_bf16 v[160:163], v[120:123], v[72:75], v[160:163]
    ds_read_b64_tr_b16 v[102:103], v2 offset:2560
    v_mfma_f32_16x16x32_bf16 v[180:183], v[120:123], v[76:79], v[180:183]
    ds_read_b64_tr_b16 v[104:105], v2 offset:32
    v_mfma_f32_16x16x32_bf16 v[200:203], v[120:123], v[80:83], v[200:203]
    ds_read_b64_tr_b16 v[106:107], v2 offset:2592
    v_mfma_f32_16x16x32_bf16 v[144:147], v[124:127], v[68:71], v[144:147]
    ds_read_b64_tr_b16 v[108:109], v2 offset:64
    v_mfma_f32_16x16x32_bf16 v[164:167], v[124:127], v[72:75], v[164:167]
    ds_read_b64_tr_b16 v[110:111], v2 offset:2624
    v_mfma_f32_16x16x32_bf16 v[184:187], v[124:127], v[76:79], v[184:187]
    ds_read_b64_tr_b16 v[112:113], v2 offset:96
    v_mfma_f32_16x16x32_bf16 v[204:207], v[124:127], v[80:83], v[204:207]
    ds_read_b64_tr_b16 v[114:115], v2 offset:2656
    v_mfma_f32_16x16x32_bf16 v[148:151], v[128:131], v[68:71], v[148:151]
    ds_read_b64_tr_b16 v[116:117], v2 offset:128
    v_mfma_f32_16x16x32_bf16 v[168:171], v[128:131], v[72:75], v[168:171]
    ds_read_b64_tr_b16 v[118:119], v2 offset:2688
    v_mfma_f32_16x16x32_bf16 v[188:191], v[128:131], v[76:79], v[188:191]
    v_mfma_f32_16x16x32_bf16 v[208:211], v[128:131], v[80:83], v[208:211]
    v_mfma_f32_16x16x32_bf16 v[152:155], v[132:135], v[68:71], v[152:155]
    v_mfma_f32_16x16x32_bf16 v[172:175], v[132:135], v[72:75], v[172:175]
    v_mfma_f32_16x16x32_bf16 v[192:195], v[132:135], v[76:79], v[192:195]
    v_mfma_f32_16x16x32_bf16 v[212:215], v[132:135], v[80:83], v[212:215]
    v_mfma_f32_16x16x32_bf16 v[156:159], v[136:139], v[68:71], v[156:159]
    v_mfma_f32_16x16x32_bf16 v[176:179], v[136:139], v[72:75], v[176:179]
    v_mfma_f32_16x16x32_bf16 v[196:199], v[136:139], v[76:79], v[196:199]
    v_mfma_f32_16x16x32_bf16 v[216:219], v[136:139], v[80:83], v[216:219]
    s_add_u32 s34, s34, 5120
    s_cmp_eq_u32 s34, 20480
    s_cselect_b32 s34, 0, s34
L_c_n3:
    s_add_u32 s35, s35, 1
    s_cmp_ge_u32 s35, s19
    s_cbranch_scc1 L_c_hdone
    s_branch L_c_loop
L_c_hdone:
    s_setprio 0
    s_waitcnt lgkmcnt(0)
    s_barrier
    s_add_u32 s33, s16, 16
    s_mul_i32 s26, s33, 40960
    s_add_u32 s26, s26, s24
    s_mul_i32 s34, s16, 5120
    s_add_u32 m0, s34, 61440
    s_nop 0
    buffer_load_dwordx4 v8, s[8:11], s26 offen offset:0 lds
    buffer_load_dwordx4 v9, s[8:11], s26 offen offset:1024 lds
    buffer_load_dwordx4 v10, s[8:11], s26 offen offset:2048 lds
    buffer_load_dwordx4 v11, s[8:11], s26 offen offset:3072 lds
    s_add_u32 m0, m0, 4096
    s_nop 0
    buffer_load_dwordx4 v12, s[8:11], s26 offen lds
    s_add_u32 s33, s16, 1
    s_and_b32 s33, s33, 3
    s_mul_i32 s33, s33, 15360
    v_add_u32 v2, s33, v13
    ds_write_b128 v2, v[160:163] offset:0
    ds_write_b128 v2, v[164:167] offset:1024
    ds_write_b128 v2, v[168:171] offset:2048
    ds_write_b128 v2, v[172:175] offset:3072
    ds_write_b128 v2, v[176:179] offset:4096
    s_add_u32 s33, s16, 2
    s_and_b32 s33, s33, 3
    s_mul_i32 s33, s33, 15360
    v_add_u32 v2, s33, v13
    ds_write_b128 v2, v[180:183] offset:5120
    ds_write_b128 v2, v[184:187] offset:6144
    ds_write_b128 v2, v[188:191] offset:7168
    ds_write_b128 v2, v[192:195] offset:8192
    ds_write_b128 v2, v[196:199] offset:9216
    s_add_u32 s33, s16, 3
    s_and_b32 s33, s33, 3
    s_mul_i32 s33, s33, 15360
    v_add_u32 v2, s33, v13
    ds_write_b128 v2, v[200:203] offset:10240
    ds_write_b128 v2, v[204:207] offset:11264
    ds_write_b128 v2, v[208:211] offset:12288
    ds_write_b128 v2, v[212:215] offset:13312
    ds_write_b128 v2, v[216:219] offset:14336
    v_sub_f32 v4, 1.0, v15
    s_mul_i32 s33, s16, 15360
    v_add_u32 v2, s33, v13
    s_waitcnt lgkmcnt(0)
    s_barrier
    ds_read_b128 v[160:163], v2 offset:0
    ds_read_b128 v[164:167], v2 offset:1024
    ds_read_b128 v[168:171], v2 offset:2048
    ds_read_b128 v[172:175], v2 offset:3072
    ds_read_b128 v[176:179], v2 offset:4096
    ds_read_b128 v[180:183], v2 offset:5120
    ds_read_b128 v[184:187], v2 offset:6144
    ds_read_b128 v[188:191], v2 offset:7168
    ds_read_b128 v[192:195], v2 offset:8192
    ds_read_b128 v[196:199], v2 offset:9216
    ds_read_b128 v[200:203], v2 offset:10240
    ds_read_b128 v[204:207], v2 offset:11264
    ds_read_b128 v[208:211], v2 offset:12288
    ds_read_b128 v[212:215], v2 offset:13312
    ds_read_b128 v[216:219], v2 offset:14336
    v_subrev_u32 v14, s17, v14
    v_add_u32 v5, 40960, v14
    v_add_u32 v6, 61440, v14
    s_waitcnt lgkmcnt(0)
    v_add_f32 v140, v140, v160
    v_add_f32 v180, v180, v200
    v_add_f32 v141, v141, v161
    v_add_f32 v181, v181, v201
    v_add_f32 v142, v142, v162
    v_add_f32 v182, v182, v202
    v_add_f32 v143, v143, v163
    v_add_f32 v183, v183, v203
    v_add_f32 v144, v144, v164
    v_add_f32 v184, v184, v204
    v_add_f32 v145, v145, v165
    v_add_f32 v185, v185, v205
    v_add_f32 v146, v146, v166
    v_add_f32 v186, v186, v206
    v_add_f32 v147, v147, v167
    v_add_f32 v187, v187, v207
    v_add_f32 v148, v148, v168
    v_add_f32 v188, v188, v208
    v_add_f32 v149, v149, v169
    v_add_f32 v189, v189, v209
    v_add_f32 v150, v150, v170
    v_add_f32 v190, v190, v210
    v_add_f32 v151, v151, v171
    v_add_f32 v191, v191, v211
    v_add_f32 v152, v152, v172
    v_add_f32 v192, v192, v212
    v_add_f32 v153, v153, v173
    v_add_f32 v193, v193, v213
    v_add_f32 v154, v154, v174
    v_add_f32 v194, v194, v214
    v_add_f32 v155, v155, v175
    v_add_f32 v195, v195, v215
    v_add_f32 v156, v156, v176
    v_add_f32 v196, v196, v216
    v_add_f32 v157, v157, v177
    v_add_f32 v197, v197, v217
    v_add_f32 v158, v158, v178
    v_add_f32 v198, v198, v218
    v_add_f32 v159, v159, v179
    v_add_f32 v199, v199, v219
    v_add_f32 v140, v140, v180
    v_mul_f32 v140, v140, v4
    v_add_f32 v141, v141, v181
    v_mul_f32 v141, v141, v4
    v_add_f32 v142, v142, v182
    v_mul_f32 v142, v142, v4
    v_add_f32 v143, v143, v183
    v_mul_f32 v143, v143, v4
    v_add_f32 v144, v144, v184
    v_mul_f32 v144, v144, v4
    v_add_f32 v145, v145, v185
    v_mul_f32 v145, v145, v4
    v_add_f32 v146, v146, v186
    v_mul_f32 v146, v146, v4
    v_add_f32 v147, v147, v187
    v_mul_f32 v147, v147, v4
    v_add_f32 v148, v148, v188
    v_mul_f32 v148, v148, v4
    v_add_f32 v149, v149, v189
    v_mul_f32 v149, v149, v4
    v_add_f32 v150, v150, v190
    v_mul_f32 v150, v150, v4
    v_add_f32 v151, v151, v191
    v_mul_f32 v151, v151, v4
    v_add_f32 v152, v152, v192
    v_mul_f32 v152, v152, v4
    v_add_f32 v153, v153, v193
    v_mul_f32 v153, v153, v4
    v_add_f32 v154, v154, v194
    v_mul_f32 v154, v154, v4
    v_add_f32 v155, v155, v195
    v_mul_f32 v155, v155, v4
    v_add_f32 v156, v156, v196
    v_mul_f32 v156, v156, v4
    v_add_f32 v157, v157, v197
    v_mul_f32 v157, v157, v4
    v_add_f32 v158, v158, v198
    v_mul_f32 v158, v158, v4
    v_add_f32 v159, v159, v199
    v_mul_f32 v159, v159, v4
    s_waitcnt vmcnt(0)
    s_barrier
    ds_read_b64_tr_b16 v[160:161], v6 offset:0
    ds_read_b64_tr_b16 v[162:163], v6 offset:2560
    ds_read_b64_tr_b16 v[164:165], v6 offset:32
    ds_read_b64_tr_b16 v[166:167], v6 offset:2592
    ds_read_b64_tr_b16 v[168:169], v6 offset:64
    ds_read_b64_tr_b16 v[170:171], v6 offset:2624
    ds_read_b64_tr_b16 v[172:173], v6 offset:96
    ds_read_b64_tr_b16 v[174:175], v6 offset:2656
    ds_read_b64_tr_b16 v[176:177], v6 offset:128
    ds_read_b64_tr_b16 v[178:179], v6 offset:2688
    ds_read_b64_tr_b16 v[180:181], v6 offset:5120
    ds_read_b64_tr_b16 v[182:183], v6 offset:7680
    ds_read_b64_tr_b16 v[184:185], v6 offset:5152
    ds_read_b64_tr_b16 v[186:187], v6 offset:7712
    ds_read_b64_tr_b16 v[188:189], v6 offset:5184
    ds_read_b64_tr_b16 v[190:191], v6 offset:7744
    ds_read_b64_tr_b16 v[192:193], v6 offset:5216
    ds_read_b64_tr_b16 v[194:195], v6 offset:7776
    ds_read_b64_tr_b16 v[196:197], v6 offset:5248
    ds_read_b64_tr_b16 v[198:199], v6 offset:7808
    s_waitcnt lgkmcnt(0)
    ds_read_b64_tr_b16 v[200:201], v6 offset:10240
    ds_read_b64_tr_b16 v[202:203], v6 offset:12800
    ds_read_b64_tr_b16 v[204:205], v6 offset:10272
    ds_read_b64_tr_b16 v[206:207], v6 offset:12832
    ds_read_b64_tr_b16 v[208:209], v6 offset:10304
    ds_read_b64_tr_b16 v[210:211], v6 offset:12864
    ds_read_b64_tr_b16 v[212:213], v6 offset:10336
    ds_read_b64_tr_b16 v[214:215], v6 offset:12896
    ds_read_b64_tr_b16 v[216:217], v6 offset:10368
    ds_read_b64_tr_b16 v[218:219], v6 offset:12928
    ds_read_b64_tr_b16 v[220:221], v6 offset:15360
    ds_read_b64_tr_b16 v[222:223], v6 offset:17920
    ds_read_b64_tr_b16 v[224:225], v6 offset:15392
    ds_read_b64_tr_b16 v[226:227], v6 offset:17952
    ds_read_b64_tr_b16 v[228:229], v6 offset:15424
    ds_read_b64_tr_b16 v[230:231], v6 offset:17984
    ds_read_b64_tr_b16 v[232:233], v6 offset:15456
    ds_read_b64_tr_b16 v[234:235], v6 offset:18016
    ds_read_b64_tr_b16 v[236:237], v6 offset:15488
    ds_read_b64_tr_b16 v[238:239], v6 offset:18048
    s_add_u32 s33, s16, 0
    s_mul_i32 s26, s33, 40960
    s_add_u32 s26, s26, s24
    s_mul_i32 m0, s33, 5120
    s_nop 0
    buffer_load_dwordx4 v8, s[8:11], s26 offen offset:0 lds
    buffer_load_dwordx4 v9, s[8:11], s26 offen offset:1024 lds
    buffer_load_dwordx4 v10, s[8:11], s26 offen offset:2048 lds
    buffer_load_dwordx4 v11, s[8:11], s26 offen offset:3072 lds
    s_add_u32 m0, m0, 4096
    s_nop 0
    buffer_load_dwordx4 v12, s[8:11], s26 offen lds
    s_add_u32 s33, s16, 4
    s_mul_i32 s26, s33, 40960
    s_add_u32 s26, s26, s24
    s_mul_i32 m0, s33, 5120
    s_nop 0
    buffer_load_dwordx4 v8, s[8:11], s26 offen offset:0 lds
    buffer_load_dwordx4 v9, s[8:11], s26 offen offset:1024 lds
    buffer_load_dwordx4 v10, s[8:11], s26 offen offset:2048 lds
    buffer_load_dwordx4 v11, s[8:11], s26 offen offset:3072 lds
    s_add_u32 m0, m0, 4096
    s_nop 0
    buffer_load_dwordx4 v12, s[8:11], s26 offen lds
    s_add_u32 s33, s16, 8
    s_mul_i32 s26, s33, 40960
    s_add_u32 s26, s26, s24
    s_mul_i32 m0, s33, 5120
    s_nop 0
    buffer_load_dwordx4 v8, s[8:11], s26 offen offset:0 lds
    buffer_load_dwordx4 v9, s[8:11], s26 offen offset:1024 lds
    buffer_load_dwordx4 v10, s[8:11], s26 offen offset:2048 lds
    buffer_load_dwordx4 v11, s[8:11], s26 offen offset:3072 lds
    s_add_u32 m0, m0, 4096
    s_nop 0
    buffer_load_dwordx4 v12, s[8:11], s26 offen lds
    s_waitcnt lgkmcnt(0)
    s_barrier
    s_add_u32 s33, s16, 12
    s_mul_i32 s26, s33, 40960
    s_add_u32 s26, s26, s24
    s_mul_i32 m0, s33, 5120
    s_nop 0
    buffer_load_dwordx4 v8, s[8:11], s26 offen offset:0 lds
    buffer_load_dwordx4 v9, s[8:11], s26 offen offset:1024 lds
    buffer_load_dwordx4 v10, s[8:11], s26 offen offset:2048 lds
    buffer_load_dwordx4 v11, s[8:11], s26 offen offset:3072 lds
    s_add_u32 m0, m0, 4096
    s_nop 0
    buffer_load_dwordx4 v12, s[8:11], s26 offen lds
    s_mul_i32 s25, s16, 75776
    s_add_u32 s25, s25, s23
    s_add_u32 s25, s25, 55296
    s_setprio 0
    s_lshr_b32 s33, s30, 2
    s_lshl_b32 s33, s33, 8
    s_add_u32 s33, s33, 7888896
    s_waitcnt vmcnt(0)
    s_cmp_eq_u32 s16, 0
    s_cbranch_scc0 L_c_o_fd
    s_mov_b32 s59, 0
    v_min_u32 v28, 31, v1
    v_lshlrev_b32 v28, 3, v28
L_c_o_fw:
    buffer_load_dwordx2 v[20:21], v28, s[12:15], s33 offen sc1
    s_waitcnt vmcnt(0)
    v_cmp_ne_u64 vcc, s[60:61], v[20:21]
    s_mov_b64 s[56:57], vcc
    s_cmp_eq_u64 s[56:57], 0
    s_cbranch_scc1 L_c_o_fd
    s_add_u32 s59, s59, 1
    s_cmp_ge_u32 s59, 0x20000
    s_cbranch_scc1 L_c_o_fd
    s_sleep 1
    s_branch L_c_o_fw
L_c_o_fd:
    s_barrier
    s_setprio 3
    buffer_load_dwordx4 v[20:23], v13, s[12:15], s25 offen offset:0 sc1
    buffer_load_dwordx4 v[24:27], v13, s[12:15], s25 offen offset:1024 sc1
    buffer_load_dwordx4 v[28:31], v13, s[12:15], s25 offen offset:2048 sc1
    buffer_load_dwordx4 v[32:35], v13, s[12:15], s25 offen offset:3072 sc1
    s_add_u32 s25, s25, 4096
    buffer_load_dwordx4 v[36:39], v13, s[12:15], s25 offen offset:0 sc1
    buffer_load_dwordx4 v[40:43], v13, s[12:15], s25 offen offset:1024 sc1
    buffer_load_dwordx4 v[44:47], v13, s[12:15], s25 offen offset:2048 sc1
    buffer_load_dwordx4 v[48:51], v13, s[12:15], s25 offen offset:3072 sc1
    s_add_u32 s25, s25, 4096
    buffer_load_dwordx4 v[52:55], v13, s[12:15], s25 offen offset:0 sc1
    buffer_load_dwordx4 v[56:59], v13, s[12:15], s25 offen offset:1024 sc1
    buffer_load_dwordx4 v[60:63], v13, s[12:15], s25 offen offset:2048 sc1
    buffer_load_dwordx4 v[64:67], v13, s[12:15], s25 offen offset:3072 sc1
    s_add_u32 s25, s25, 4096
    buffer_load_dwordx4 v[68:71], v13, s[12:15], s25 offen offset:0 sc1
    buffer_load_dwordx4 v[72:75], v13, s[12:15], s25 offen offset:1024 sc1
    buffer_load_dwordx4 v[76:79], v13, s[12:15], s25 offen offset:2048 sc1
    buffer_load_dwordx4 v[80:83], v13, s[12:15], s25 offen offset:3072 sc1
    s_add_u32 s25, s25, 4096
    buffer_load_dwordx4 v[84:87], v13, s[12:15], s25 offen offset:0 sc1
    buffer_load_dwordx4 v[88:91], v13, s[12:15], s25 offen offset:1024 sc1
    buffer_load_dwordx4 v[92:95], v13, s[12:15], s25 offen offset:2048 sc1
    buffer_load_dwordx4 v[96:99], v13, s[12:15], s25 offen offset:3072 sc1
    ds_read_b64_tr_b16 v[100:101], v14 offset:0
    ds_read_b64_tr_b16 v[102:103], v14 offset:2560
    ds_read_b64_tr_b16 v[104:105], v14 offset:32
    ds_read_b64_tr_b16 v[106:107], v14 offset:2592
    ds_read_b64_tr_b16 v[108:109], v14 offset:64
    ds_read_b64_tr_b16 v[110:111], v14 offset:2624
    ds_read_b64_tr_b16 v[112:113], v14 offset:96
    ds_read_b64_tr_b16 v[114:115], v14 offset:2656
    ds_read_b64_tr_b16 v[116:117], v14 offset:128
    ds_read_b64_tr_b16 v[118:119], v14 offset:2688
    s_waitcnt vmcnt(19) lgkmcnt(0)
    v_mfma_f32_16x16x32_bf16 v[140:143], v[100:103], v[20:23], v[140:143]
    ds_read_b64_tr_b16 v[120:121], v14 offset:5120
    ds_read_b64_tr_b16 v[122:123], v14 offset:7680
    v_mfma_f32_16x16x32_bf16 v[144:147], v[104:107], v[20:23], v[144:147]
    ds_read_b64_tr_b16 v[124:125], v14 offset:5152
    ds_read_b64_tr_b16 v[126:127], v14 offset:7712
    v_mfma_f32_16x16x32_bf16 v[148:151], v[108:111], v[20:23], v[148:151]
    ds_read_b64_tr_b16 v[128:129], v14 offset:5184
    ds_read_b64_tr_b16 v[130:131], v14 offset:7744
    v_mfma_f32_16x16x32_bf16 v[152:155], v[112:115], v[20:23], v[152:155]
    ds_read_b64_tr_b16 v[132:133], v14 offset:5216
    ds_read_b64_tr_b16 v[134:135], v14 offset:7776
    v_mfma_f32_16x16x32_bf16 v[156:159], v[116:119], v[20:23], v[156:159]
    ds_read_b64_tr_b16 v[136:137], v14 offset:5248
    ds_read_b64_tr_b16 v[138:139], v14 offset:7808
    s_waitcnt vmcnt(18) lgkmcnt(0)
    v_mfma_f32_16x16x32_bf16 v[140:143], v[120:123], v[24:27], v[140:143]
    ds_read_b64_tr_b16 v[100:101], v14 offset:10240
    ds_read_b64_tr_b16 v[102:103], v14 offset:12800
    v_mfma_f32_16x16x32_bf16 v[144:147], v[124:127], v[24:27], v[144:147]
    ds_read_b64_tr_b16 v[104:105], v14 offset:10272
    ds_read_b64_tr_b16 v[106:107], v14 offset:12832
    v_mfma_f32_16x16x32_bf16 v[148:151], v[128:131], v[24:27], v[148:151]
    ds_read_b64_tr_b16 v[108:109], v14 offset:10304
    ds_read_b64_tr_b16 v[110:111], v14 offset:12864
    v_mfma_f32_16x16x32_bf16 v[152:155], v[132:135], v[24:27], v[152:155]
    ds_read_b64_tr_b16 v[112:113], v14 offset:10336
    ds_read_b64_tr_b16 v[114:115], v14 offset:12896
    v_mfma_f32_16x16x32_bf16 v[156:159], v[136:139], v[24:27], v[156:159]
    ds_read_b64_tr_b16 v[116:117], v14 offset:10368
    ds_read_b64_tr_b16 v[118:119], v14 offset:12928
    s_waitcnt vmcnt(17) lgkmcnt(0)
    v_mfma_f32_16x16x32_bf16 v[140:143], v[100:103], v[28:31], v[140:143]
    ds_read_b64_tr_b16 v[120:121], v14 offset:15360
    ds_read_b64_tr_b16 v[122:123], v14 offset:17920
    v_mfma_f32_16x16x32_bf16 v[144:147], v[104:107], v[28:31], v[144:147]
    ds_read_b64_tr_b16 v[124:125], v14 offset:15392
    ds_read_b64_tr_b16 v[126:127], v14 offset:17952
    v_mfma_f32_16x16x32_bf16 v[148:151], v[108:111], v[28:31], v[148:151]
    ds_read_b64_tr_b16 v[128:129], v14 offset:15424
    ds_read_b64_tr_b16 v[130:131], v14 offset:17984
    v_mfma_f32_16x16x32_bf16 v[152:155], v[112:115], v[28:31], v[152:155]
    ds_read_b64_tr_b16 v[132:133], v14 offset:15456
    ds_read_b64_tr_b16 v[134:135], v14 offset:18016
    v_mfma_f32_16x16x32_bf16 v[156:159], v[116:119], v[28:31], v[156:159]
    ds_read_b64_tr_b16 v[136:137], v14 offset:15488
    ds_read_b64_tr_b16 v[138:139], v14 offset:18048
    s_waitcnt vmcnt(16) lgkmcnt(0)
    v_mfma_f32_16x16x32_bf16 v[140:143], v[120:123], v[32:35], v[140:143]
    ds_read_b64_tr_b16 v[100:101], v14 offset:20480
    ds_read_b64_tr_b16 v[102:103], v14 offset:23040
    v_mfma_f32_16x16x32_bf16 v[144:147], v[124:127], v[32:35], v[144:147]
    ds_read_b64_tr_b16 v[104:105], v14 offset:20512
    ds_read_b64_tr_b16 v[106:107], v14 offset:23072
    v_mfma_f32_16x16x32_bf16 v[148:151], v[128:131], v[32:35], v[148:151]
    ds_read_b64_tr_b16 v[108:109], v14 offset:20544
    ds_read_b64_tr_b16 v[110:111], v14 offset:23104
    v_mfma_f32_16x16x32_bf16 v[152:155], v[132:135], v[32:35], v[152:155]
    ds_read_b64_tr_b16 v[112:113], v14 offset:20576
    ds_read_b64_tr_b16 v[114:115], v14 offset:23136
    v_mfma_f32_16x16x32_bf16 v[156:159], v[136:139], v[32:35], v[156:159]
    ds_read_b64_tr_b16 v[116:117], v14 offset:20608
    ds_read_b64_tr_b16 v[118:119], v14 offset:23168
    s_waitcnt vmcnt(15) lgkmcnt(0)
    v_mfma_f32_16x16x32_bf16 v[140:143], v[100:103], v[36:39], v[140:143]
    ds_read_b64_tr_b16 v[120:121], v14 offset:25600
    ds_read_b64_tr_b16 v[122:123], v14 offset:28160
    v_mfma_f32_16x16x32_bf16 v[144:147], v[104:107], v[36:39], v[144:147]
    ds_read_b64_tr_b16 v[124:125], v14 offset:25632
    ds_read_b64_tr_b16 v[126:127], v14 offset:28192
    v_mfma_f32_16x16x32_bf16 v[148:151], v[108:111], v[36:39], v[148:151]
    ds_read_b64_tr_b16 v[128:129], v14 offset:25664
    ds_read_b64_tr_b16 v[130:131], v14 offset:28224
    v_mfma_f32_16x16x32_bf16 v[152:155], v[112:115], v[36:39], v[152:155]
    ds_read_b64_tr_b16 v[132:133], v14 offset:25696
    ds_read_b64_tr_b16 v[134:135], v14 offset:28256
    v_mfma_f32_16x16x32_bf16 v[156:159], v[116:119], v[36:39], v[156:159]
    ds_read_b64_tr_b16 v[136:137], v14 offset:25728
    ds_read_b64_tr_b16 v[138:139], v14 offset:28288
    s_waitcnt vmcnt(14) lgkmcnt(0)
    v_mfma_f32_16x16x32_bf16 v[140:143], v[120:123], v[40:43], v[140:143]
    ds_read_b64_tr_b16 v[100:101], v14 offset:30720
    ds_read_b64_tr_b16 v[102:103], v14 offset:33280
    v_mfma_f32_16x16x32_bf16 v[144:147], v[124:127], v[40:43], v[144:147]
    ds_read_b64_tr_b16 v[104:105], v14 offset:30752
    ds_read_b64_tr_b16 v[106:107], v14 offset:33312
    v_mfma_f32_16x16x32_bf16 v[148:151], v[128:131], v[40:43], v[148:151]
    ds_read_b64_tr_b16 v[108:109], v14 offset:30784
    ds_read_b64_tr_b16 v[110:111], v14 offset:33344
    v_mfma_f32_16x16x32_bf16 v[152:155], v[132:135], v[40:43], v[152:155]
    ds_read_b64_tr_b16 v[112:113], v14 offset:30816
    ds_read_b64_tr_b16 v[114:115], v14 offset:33376
    v_mfma_f32_16x16x32_bf16 v[156:159], v[136:139], v[40:43], v[156:159]
    ds_read_b64_tr_b16 v[116:117], v14 offset:30848
    ds_read_b64_tr_b16 v[118:119], v14 offset:33408
    s_waitcnt vmcnt(13) lgkmcnt(0)
    v_mfma_f32_16x16x32_bf16 v[140:143], v[100:103], v[44:47], v[140:143]
    ds_read_b64_tr_b16 v[120:121], v14 offset:35840
    ds_read_b64_tr_b16 v[122:123], v14 offset:38400
    v_mfma_f32_16x16x32_bf16 v[144:147], v[104:107], v[44:47], v[144:147]
    ds_read_b64_tr_b16 v[124:125], v14 offset:35872
    ds_read_b64_tr_b16 v[126:127], v14 offset:38432
    v_mfma_f32_16x16x32_bf16 v[148:151], v[108:111], v[44:47], v[148:151]
    ds_read_b64_tr_b16 v[128:129], v14 offset:35904
    ds_read_b64_tr_b16 v[130:131], v14 offset:38464
    v_mfma_f32_16x16x32_bf16 v[152:155], v[112:115], v[44:47], v[152:155]
    ds_read_b64_tr_b16 v[132:133], v14 offset:35936
    ds_read_b64_tr_b16 v[134:135], v14 offset:38496
    v_mfma_f32_16x16x32_bf16 v[156:159], v[116:119], v[44:47], v[156:159]
    ds_read_b64_tr_b16 v[136:137], v14 offset:35968
    ds_read_b64_tr_b16 v[138:139], v14 offset:38528
    s_waitcnt vmcnt(12) lgkmcnt(0)
    v_mfma_f32_16x16x32_bf16 v[140:143], v[120:123], v[48:51], v[140:143]
    ds_read_b64_tr_b16 v[100:101], v5 offset:0
    ds_read_b64_tr_b16 v[102:103], v5 offset:2560
    v_mfma_f32_16x16x32_bf16 v[144:147], v[124:127], v[48:51], v[144:147]
    ds_read_b64_tr_b16 v[104:105], v5 offset:32
    ds_read_b64_tr_b16 v[106:107], v5 offset:2592
    v_mfma_f32_16x16x32_bf16 v[148:151], v[128:131], v[48:51], v[148:151]
    ds_read_b64_tr_b16 v[108:109], v5 offset:64
    ds_read_b64_tr_b16 v[110:111], v5 offset:2624
    v_mfma_f32_16x16x32_bf16 v[152:155], v[132:135], v[48:51], v[152:155]
    ds_read_b64_tr_b16 v[112:113], v5 offset:96
    ds_read_b64_tr_b16 v[114:115], v5 offset:2656
    v_mfma_f32_16x16x32_bf16 v[156:159], v[136:139], v[48:51], v[156:159]
    ds_read_b64_tr_b16 v[116:117], v5 offset:128
    ds_read_b64_tr_b16 v[118:119], v5 offset:2688
    s_waitcnt vmcnt(11) lgkmcnt(0)
    v_mfma_f32_16x16x32_bf16 v[140:143], v[100:103], v[52:55], v[140:143]
    ds_read_b64_tr_b16 v[120:121], v5 offset:5120
    ds_read_b64_tr_b16 v[122:123], v5 offset:7680
    v_mfma_f32_16x16x32_bf16 v[144:147], v[104:107], v[52:55], v[144:147]
    ds_read_b64_tr_b16 v[124:125], v5 offset:5152
    ds_read_b64_tr_b16 v[126:127], v5 offset:7712
    v_mfma_f32_16x16x32_bf16 v[148:151], v[108:111], v[52:55], v[148:151]
    ds_read_b64_tr_b16 v[128:129], v5 offset:5184
    ds_read_b64_tr_b16 v[130:131], v5 offset:7744
    v_mfma_f32_16x16x32_bf16 v[152:155], v[112:115], v[52:55], v[152:155]
    ds_read_b64_tr_b16 v[132:133], v5 offset:5216
    ds_read_b64_tr_b16 v[134:135], v5 offset:7776
    v_mfma_f32_16x16x32_bf16 v[156:159], v[116:119], v[52:55], v[156:159]
    ds_read_b64_tr_b16 v[136:137], v5 offset:5248
    ds_read_b64_tr_b16 v[138:139], v5 offset:7808
    s_waitcnt vmcnt(10) lgkmcnt(0)
    v_mfma_f32_16x16x32_bf16 v[140:143], v[120:123], v[56:59], v[140:143]
    ds_read_b64_tr_b16 v[100:101], v5 offset:10240
    ds_read_b64_tr_b16 v[102:103], v5 offset:12800
    v_mfma_f32_16x16x32_bf16 v[144:147], v[124:127], v[56:59], v[144:147]
    ds_read_b64_tr_b16 v[104:105], v5 offset:10272
    ds_read_b64_tr_b16 v[106:107], v5 offset:12832
    v_mfma_f32_16x16x32_bf16 v[148:151], v[128:131], v[56:59], v[148:151]
    ds_read_b64_tr_b16 v[108:109], v5 offset:10304
    ds_read_b64_tr_b16 v[110:111], v5 offset:12864
    v_mfma_f32_16x16x32_bf16 v[152:155], v[132:135], v[56:59], v[152:155]
    ds_read_b64_tr_b16 v[112:113], v5 offset:10336
    ds_read_b64_tr_b16 v[114:115], v5 offset:12896
    v_mfma_f32_16x16x32_bf16 v[156:159], v[136:139], v[56:59], v[156:159]
    ds_read_b64_tr_b16 v[116:117], v5 offset:10368
    ds_read_b64_tr_b16 v[118:119], v5 offset:12928
    s_waitcnt vmcnt(9) lgkmcnt(0)
    v_mfma_f32_16x16x32_bf16 v[140:143], v[100:103], v[60:63], v[140:143]
    ds_read_b64_tr_b16 v[120:121], v5 offset:15360
    ds_read_b64_tr_b16 v[122:123], v5 offset:17920
    v_mfma_f32_16x16x32_bf16 v[144:147], v[104:107], v[60:63], v[144:147]
    ds_read_b64_tr_b16 v[124:125], v5 offset:15392
    ds_read_b64_tr_b16 v[126:127], v5 offset:17952
    v_mfma_f32_16x16x32_bf16 v[148:151], v[108:111], v[60:63], v[148:151]
    ds_read_b64_tr_b16 v[128:129], v5 offset:15424
    ds_read_b64_tr_b16 v[130:131], v5 offset:17984
    v_mfma_f32_16x16x32_bf16 v[152:155], v[112:115], v[60:63], v[152:155]
    ds_read_b64_tr_b16 v[132:133], v5 offset:15456
    ds_read_b64_tr_b16 v[134:135], v5 offset:18016
    v_mfma_f32_16x16x32_bf16 v[156:159], v[116:119], v[60:63], v[156:159]
    ds_read_b64_tr_b16 v[136:137], v5 offset:15488
    ds_read_b64_tr_b16 v[138:139], v5 offset:18048
    s_waitcnt vmcnt(8) lgkmcnt(0)
    v_mfma_f32_16x16x32_bf16 v[140:143], v[120:123], v[64:67], v[140:143]
    ds_read_b64_tr_b16 v[100:101], v5 offset:20480
    ds_read_b64_tr_b16 v[102:103], v5 offset:23040
    v_mfma_f32_16x16x32_bf16 v[144:147], v[124:127], v[64:67], v[144:147]
    ds_read_b64_tr_b16 v[104:105], v5 offset:20512
    ds_read_b64_tr_b16 v[106:107], v5 offset:23072
    v_mfma_f32_16x16x32_bf16 v[148:151], v[128:131], v[64:67], v[148:151]
    ds_read_b64_tr_b16 v[108:109], v5 offset:20544
    ds_read_b64_tr_b16 v[110:111], v5 offset:23104
    v_mfma_f32_16x16x32_bf16 v[152:155], v[132:135], v[64:67], v[152:155]
    ds_read_b64_tr_b16 v[112:113], v5 offset:20576
    ds_read_b64_tr_b16 v[114:115], v5 offset:23136
    v_mfma_f32_16x16x32_bf16 v[156:159], v[136:139], v[64:67], v[156:159]
    ds_read_b64_tr_b16 v[116:117], v5 offset:20608
    ds_read_b64_tr_b16 v[118:119], v5 offset:23168
    s_waitcnt vmcnt(7) lgkmcnt(0)
    v_mfma_f32_16x16x32_bf16 v[140:143], v[100:103], v[68:71], v[140:143]
    ds_read_b64_tr_b16 v[120:121], v5 offset:25600
    ds_read_b64_tr_b16 v[122:123], v5 offset:28160
    v_mfma_f32_16x16x32_bf16 v[144:147], v[104:107], v[68:71], v[144:147]
    ds_read_b64_tr_b16 v[124:125], v5 offset:25632
    ds_read_b64_tr_b16 v[126:127], v5 offset:28192
    v_mfma_f32_16x16x32_bf16 v[148:151], v[108:111], v[68:71], v[148:151]
    ds_read_b64_tr_b16 v[128:129], v5 offset:25664
    ds_read_b64_tr_b16 v[130:131], v5 offset:28224
    v_mfma_f32_16x16x32_bf16 v[152:155], v[112:115], v[68:71], v[152:155]
    ds_read_b64_tr_b16 v[132:133], v5 offset:25696
    ds_read_b64_tr_b16 v[134:135], v5 offset:28256
    v_mfma_f32_16x16x32_bf16 v[156:159], v[116:119], v[68:71], v[156:159]
    ds_read_b64_tr_b16 v[136:137], v5 offset:25728
    ds_read_b64_tr_b16 v[138:139], v5 offset:28288
    s_waitcnt vmcnt(6) lgkmcnt(0)
    v_mfma_f32_16x16x32_bf16 v[140:143], v[120:123], v[72:75], v[140:143]
    ds_read_b64_tr_b16 v[100:101], v5 offset:30720
    ds_read_b64_tr_b16 v[102:103], v5 offset:33280
    v_mfma_f32_16x16x32_bf16 v[144:147], v[124:127], v[72:75], v[144:147]
    ds_read_b64_tr_b16 v[104:105], v5 offset:30752
    ds_read_b64_tr_b16 v[106:107], v5 offset:33312
    v_mfma_f32_16x16x32_bf16 v[148:151], v[128:131], v[72:75], v[148:151]
    ds_read_b64_tr_b16 v[108:109], v5 offset:30784
    ds_read_b64_tr_b16 v[110:111], v5 offset:33344
    v_mfma_f32_16x16x32_bf16 v[152:155], v[132:135], v[72:75], v[152:155]
    ds_read_b64_tr_b16 v[112:113], v5 offset:30816
    ds_read_b64_tr_b16 v[114:115], v5 offset:33376
    v_mfma_f32_16x16x32_bf16 v[156:159], v[136:139], v[72:75], v[156:159]
    ds_read_b64_tr_b16 v[116:117], v5 offset:30848
    ds_read_b64_tr_b16 v[118:119], v5 offset:33408
    s_waitcnt vmcnt(5) lgkmcnt(0)
    v_mfma_f32_16x16x32_bf16 v[140:143], v[100:103], v[76:79], v[140:143]
    ds_read_b64_tr_b16 v[120:121], v5 offset:35840
    ds_read_b64_tr_b16 v[122:123], v5 offset:38400
    v_mfma_f32_16x16x32_bf16 v[144:147], v[104:107], v[76:79], v[144:147]
    ds_read_b64_tr_b16 v[124:125], v5 offset:35872
    ds_read_b64_tr_b16 v[126:127], v5 offset:38432
    v_mfma_f32_16x16x32_bf16 v[148:151], v[108:111], v[76:79], v[148:151]
    ds_read_b64_tr_b16 v[128:129], v5 offset:35904
    ds_read_b64_tr_b16 v[130:131], v5 offset:38464
    v_mfma_f32_16x16x32_bf16 v[152:155], v[112:115], v[76:79], v[152:155]
    ds_read_b64_tr_b16 v[132:133], v5 offset:35936
    ds_read_b64_tr_b16 v[134:135], v5 offset:38496
    v_mfma_f32_16x16x32_bf16 v[156:159], v[116:119], v[76:79], v[156:159]
    ds_read_b64_tr_b16 v[136:137], v5 offset:35968
    ds_read_b64_tr_b16 v[138:139], v5 offset:38528
    s_waitcnt vmcnt(4) lgkmcnt(0)
    v_mfma_f32_16x16x32_bf16 v[140:143], v[120:123], v[80:83], v[140:143]
    v_mfma_f32_16x16x32_bf16 v[144:147], v[124:127], v[80:83], v[144:147]
    v_mfma_f32_16x16x32_bf16 v[148:151], v[128:131], v[80:83], v[148:151]
    v_mfma_f32_16x16x32_bf16 v[152:155], v[132:135], v[80:83], v[152:155]
    v_mfma_f32_16x16x32_bf16 v[156:159], v[136:139], v[80:83], v[156:159]
    s_waitcnt vmcnt(3)
    v_mfma_f32_16x16x32_bf16 v[140:143], v[160:163], v[84:87], v[140:143]
    v_mfma_f32_16x16x32_bf16 v[144:147], v[164:167], v[84:87], v[144:147]
    v_mfma_f32_16x16x32_bf16 v[148:151], v[168:171], v[84:87], v[148:151]
    v_mfma_f32_16x16x32_bf16 v[152:155], v[172:175], v[84:87], v[152:155]
    v_mfma_f32_16x16x32_bf16 v[156:159], v[176:179], v[84:87], v[156:159]
    s_waitcnt vmcnt(2)
    v_mfma_f32_16x16x32_bf16 v[140:143], v[180:183], v[88:91], v[140:143]
    v_mfma_f32_16x16x32_bf16 v[144:147], v[184:187], v[88:91], v[144:147]
    v_mfma_f32_16x16x32_bf16 v[148:151], v[188:191], v[88:91], v[148:151]
    v_mfma_f32_16x16x32_bf16 v[152:155], v[192:195], v[88:91], v[152:155]
    v_mfma_f32_16x16x32_bf16 v[156:159], v[196:199], v[88:91], v[156:159]
    s_waitcnt vmcnt(1)
    v_mfma_f32_16x16x32_bf16 v[140:143], v[200:203], v[92:95], v[140:143]
    v_mfma_f32_16x16x32_bf16 v[144:147], v[204:207], v[92:95], v[144:147]
    v_mfma_f32_16x16x32_bf16 v[148:151], v[208:211], v[92:95], v[148:151]
    v_mfma_f32_16x16x32_bf16 v[152:155], v[212:215], v[92:95], v[152:155]
    v_mfma_f32_16x16x32_bf16 v[156:159], v[216:219], v[92:95], v[156:159]
    s_waitcnt vmcnt(0)
    v_mfma_f32_16x16x32_bf16 v[140:143], v[220:223], v[96:99], v[140:143]
    v_mfma_f32_16x16x32_bf16 v[144:147], v[224:227], v[96:99], v[144:147]
    v_mfma_f32_16x16x32_bf16 v[148:151], v[228:231], v[96:99], v[148:151]
    v_mfma_f32_16x16x32_bf16 v[152:155], v[232:235], v[96:99], v[152:155]
    v_mfma_f32_16x16x32_bf16 v[156:159], v[236:239], v[96:99], v[156:159]
    s_nop 7
    v_and_b32 v2, 15, v1
    v_mul_u32_u24 v2, 1280, v2
    v_lshrrev_b32 v3, 4, v1
    v_lshl_add_u32 v2, v3, 3, v2
    s_lshl_b32 s35, s30, 2
    s_add_u32 s35, s35, s16
    s_mul_i32 s35, s35, 20480
    s_add_u32 s35, s35, s24
    v_cvt_pk_bf16_f32 v100, v140, v141
    v_cvt_pk_bf16_f32 v101, v142, v143
    buffer_store_dwordx2 v[100:101], v2, s[52:55], s35 offen offset:0 nt
    v_cvt_pk_bf16_f32 v102, v144, v145
    v_cvt_pk_bf16_f32 v103, v146, v147
    buffer_store_dwordx2 v[102:103], v2, s[52:55], s35 offen offset:32 nt
    v_cvt_pk_bf16_f32 v104, v148, v149
    v_cvt_pk_bf16_f32 v105, v150, v151
    buffer_store_dwordx2 v[104:105], v2, s[52:55], s35 offen offset:64 nt
    v_cvt_pk_bf16_f32 v106, v152, v153
    v_cvt_pk_bf16_f32 v107, v154, v155
    buffer_store_dwordx2 v[106:107], v2, s[52:55], s35 offen offset:96 nt
    v_cvt_pk_bf16_f32 v108, v156, v157
    v_cvt_pk_bf16_f32 v109, v158, v159
    buffer_store_dwordx2 v[108:109], v2, s[52:55], s35 offen offset:128 nt
L_pend:
L_end:
    s_endpgm
.section .rodata,"a"
.p2align 6
.amdhsa_kernel gated_mix__mha_block__glu_gated_glu__prompt_kernel
  .amdhsa_next_free_vgpr 240
  .amdhsa_next_free_sgpr 96
  .amdhsa_accum_offset 240
  .amdhsa_group_segment_fixed_size 0
  .amdhsa_kernarg_size 88
  .amdhsa_user_sgpr_count 2
  .amdhsa_user_sgpr_kernarg_segment_ptr 1
  .amdhsa_system_sgpr_workgroup_id_x 1
  .amdhsa_float_denorm_mode_32 3
.end_amdhsa_kernel
```
